```python
import torch

def _softmax(x, axis=-1):
    return torch.softmax(x, dim=axis)
def _gelu(x):
    return torch.nn.functional.gelu(x, approximate="tanh")
def _silu(x):
    return torch.nn.functional.silu(x)
def _sigmoid(x):
    return torch.sigmoid(x)
def _layernorm(x, axis=-1, eps=1e-5):
    m = x.mean(dim=axis, keepdim=True)
    v = x.var(dim=axis, keepdim=True, unbiased=False)
    return (x - m) / torch.sqrt(v + eps)
def _scatter_add(tgt, idx, src, axis=0):
    return tgt.clone().index_add_(axis, idx, src)
def _segment_sum(src, seg, n):
    out = torch.zeros((n,) + src.shape[1:], dtype=src.dtype)
    return out.index_add_(0, seg, src)
def _pad(x, pw):
    flat = tuple(v for pair in reversed(pw) for v in pair)
    return torch.nn.functional.pad(x, flat)

kernel_name = 'interleave_layers__mha_block_cached__compressed_kv_cla__decode'

def setup_inputs():

    _w = (lambda a: (lambda t: t.to(torch.bfloat16) if t.is_floating_point() else t)(torch.as_tensor(a)))
    def _A_setup():
        B, Sq, D = 1, 1, 576
        H, Sk, Dh = 32, 8192, 128
        return {
            "x": _w((lambda *s: torch.randn(*s, dtype=torch.bfloat16) * 0.05)(B, Sq, D)),
            "k_cache": _w((lambda *s: torch.randn(*s, dtype=torch.bfloat16) * 0.8)(B, H, Sk, Dh)),
            "v_cache": _w((lambda *s: torch.randn(*s, dtype=torch.bfloat16) * 1.6)(B, H, Sk, Dh)),
            "wq": _w((lambda *s: torch.randn(*s, dtype=torch.bfloat16) * 0.8)(D, H * Dh) * (D ** -0.5)),
            "wo": _w((lambda *s: torch.randn(*s, dtype=torch.bfloat16) * 1.6)(H * Dh, D) * ((H * Dh) ** -0.5)),
        }
    _A_in = _A_setup()

    def _B_setup():
        B, H, Sq, Sk, D, M = 1, 32, 1, 8192, 128, 576
        Dc = 4 * D
        return {
            "x": _w((lambda *s: torch.randn(*s, dtype=torch.bfloat16) * 0.05)(B, Sq, M)),
            "c_kv": _w((lambda *s: torch.randn(*s, dtype=torch.bfloat16) * 0.4)(B, Sk, Dc)),
            "w_q": _w((lambda *s: torch.randn(*s, dtype=torch.bfloat16) * 3.2)(M, H, D) * (M ** -0.5)),
            "w_uk": _w((lambda *s: torch.randn(*s, dtype=torch.bfloat16) * 3.2)(Dc, H, D) * (Dc ** -0.5)),
            "w_uv": _w((lambda *s: torch.randn(*s, dtype=torch.bfloat16) * 0.4)(Dc, H, D) * (Dc ** -0.5)),
            "w_o": _w((lambda *s: torch.randn(*s, dtype=torch.bfloat16) * 0.4)(H, D, M) * ((H * D) ** -0.5)),
        }
    _B_in = _B_setup()

    return {
        "A_x": _A_in["x"],
        "A_k_cache": _A_in["k_cache"],
        "A_v_cache": _A_in["v_cache"],
        "A_wq": _A_in["wq"],
        "A_wo": _A_in["wo"],
        "B_x": _B_in["x"],
        "B_c_kv": _B_in["c_kv"],
        "B_w_q": _B_in["w_q"],
        "B_w_uk": _B_in["w_uk"],
        "B_w_uv": _B_in["w_uv"],
        "B_w_o": _B_in["w_o"],
    }

def reference(A_x, A_k_cache, A_v_cache, A_wq, A_wo, B_x, B_c_kv, B_w_q, B_w_uk, B_w_uv, B_w_o):
    def _A_ref(x, k_cache, v_cache, wq, wo):
        B, Sq, D = x.shape
        H, Dh = 32, 128
        q = (lambda x, *d: x.permute(*d))((x @ wq).reshape(B, Sq, H, Dh), 0, 2, 1, 3)
        scores = torch.einsum("bhqd,bhkd->bhqk", q, k_cache) * (Dh ** -0.5)
        p = _softmax(scores, axis=-1)
        o = torch.einsum("bhqk,bhkd->bhqd", p, v_cache)
        return (lambda x, *d: x.permute(*d))(o, 0, 2, 1, 3).reshape(B, Sq, H * Dh) @ wo

    def _B_ref(x, c_kv, w_q, w_uk, w_uv, w_o):
        B, Sq, M = x.shape[0], x.shape[1], x.shape[2]
        Sk = c_kv.shape[1]
        H, D = w_q.shape[1], w_q.shape[2]
        q = torch.einsum("bqm,mhd->bhqd", x, w_q)
        k = torch.einsum("bkc,chd->bhkd", c_kv, w_uk)
        v = torch.einsum("bkc,chd->bhkd", c_kv, w_uv)
        scores = torch.einsum("bhqd,bhkd->bhqk", q, k) * (D ** -0.5)
        off = Sk - Sq
        qi = torch.arange(Sq)[:, None]
        kj = torch.arange(Sk)[None, :]
        cmask = kj <= (qi + off)
        scores = torch.where(cmask[None, None], scores, -1e9)
        p = _softmax(scores, axis=-1)
        ctx = torch.einsum("bhqk,bhkd->bhqd", p, v)
        return torch.einsum("bhqd,hdm->bqm", ctx, w_o)

    x = A_x
    x = x + _A_ref(_layernorm(x, axis=-1), A_k_cache, A_v_cache, A_wq, A_wo)
    x = x + _B_ref(_layernorm(x, axis=-1), B_c_kv, B_w_q, B_w_uk, B_w_uv, B_w_o)
    x = x + _A_ref(_layernorm(x, axis=-1), A_k_cache, A_v_cache, A_wq, A_wo)
    x = x + _B_ref(_layernorm(x, axis=-1), B_c_kv, B_w_q, B_w_uk, B_w_uv, B_w_o)
    return x
```

```asm
; @launch grid=(256,1,1) block=(256,1,1) lds=163840
.amdgcn_target "amdgcn-amd-amdhsa--gfx950"
.text
.globl interleave_layers__mha_block_cached__compressed_kv_cla__decode_kernel
.p2align 8
.type interleave_layers__mha_block_cached__compressed_kv_cla__decode_kernel,@function
interleave_layers__mha_block_cached__compressed_kv_cla__decode_kernel:
    s_cmp_ge_u32 s2, 256
    s_cbranch_scc1 L_end
    s_load_dwordx2 s[4:5], s[0:1], 8
    s_getpc_b64 s[82:83]
L_pc:
    s_and_b32 s3, s2, 0xf8
    v_lshrrev_b32 v62, 5, v0
    v_add_lshl_u32 v62, v62, s3, 7
    v_min_u32 v62, L_codeend-L_pc, v62
    global_load_dword v61, v62, s[82:83]
    v_lshrrev_b32 v1, 6, v0
    v_mov_b32 v63, v0
    v_readfirstlane_b32 s66, v1
    v_and_b32 v0, 63, v0
    s_and_b32 s64, s2, 7
    s_lshr_b32 s65, s2, 3
    s_lshl_b32 s69, s66, 14
    s_lshl_b32 s70, s64, 23
    s_lshl_b32 s78, s65, 18
    s_add_u32 s70, s70, s78
    s_lshl_b32 s78, s66, 12
    s_add_u32 s70, s70, s78
    v_lshlrev_b32 v6, 4, v0
    v_and_b32 v12, 48, v0
    v_lshlrev_b32 v12, 1, v12
    v_xor_b32 v8, v12, v6
    v_xor_b32 v9, 128, v8
    v_xor_b32 v10, 144, v8
    v_xor_b32 v11, 16, v8
    s_mov_b32 s6, 67108864
    s_mov_b32 s7, 0x20000
    s_waitcnt lgkmcnt(0)
    s_add_u32 m0, s69, 0
    s_add_u32 s78, s70, 0
    buffer_load_dwordx4 v8, s[4:7], s78 offen offset:0 nt lds
    buffer_load_dwordx4 v9, s[4:7], s78 offen offset:1024 nt lds
    buffer_load_dwordx4 v10, s[4:7], s78 offen offset:2048 nt lds
    buffer_load_dwordx4 v11, s[4:7], s78 offen offset:3072 nt lds
    s_load_dwordx2 s[8:9], s[0:1], 16
    s_load_dwordx2 s[12:13], s[0:1], 48
    s_load_dwordx2 s[16:17], s[0:1], 96
    s_add_u32 m0, s69, 4096
    s_add_u32 s78, s70, 16384
    buffer_load_dwordx4 v8, s[4:7], s78 offen offset:0 nt lds
    buffer_load_dwordx4 v9, s[4:7], s78 offen offset:1024 nt lds
    s_load_dwordx2 s[20:21], s[0:1], 0
    s_load_dwordx2 s[24:25], s[0:1], 24
    s_load_dwordx2 s[28:29], s[0:1], 32
    s_load_dwordx2 s[32:33], s[0:1], 56
    s_load_dwordx2 s[36:37], s[0:1], 64
    s_load_dwordx2 s[40:41], s[0:1], 72
    s_load_dwordx2 s[44:45], s[0:1], 80
    s_load_dwordx2 s[48:49], s[0:1], 104
    s_load_dwordx2 s[60:61], s[0:1], 88
    s_mov_b32 s10, 67108864
    s_mov_b32 s11, 0x20000
    s_mov_b32 s14, 8388608
    s_mov_b32 s15, 0x20000
    s_mov_b32 s18, 256
    s_mov_b32 s19, 0x20000
    s_mov_b32 s22, 1152
    s_mov_b32 s23, 0x20000
    s_mov_b32 s26, 4718592
    s_mov_b32 s27, 0x20000
    s_mov_b32 s30, 4718592
    s_mov_b32 s31, 0x20000
    s_mov_b32 s34, 4718592
    s_mov_b32 s35, 0x20000
    s_mov_b32 s38, 4194304
    s_mov_b32 s39, 0x20000
    s_mov_b32 s42, 4194304
    s_mov_b32 s43, 0x20000
    s_mov_b32 s46, 4718592
    s_mov_b32 s47, 0x20000
    s_mov_b32 s50, 16777216
    s_mov_b32 s51, 0x20000
    s_mov_b32 s54, 131072
    s_mov_b32 s55, 0x20000
    s_mov_b32 s58, 393216
    s_mov_b32 s59, 0x20000
    s_mov_b32 s62, 1152
    s_mov_b32 s63, 0x20000
    s_lshr_b32 s79, s65, 3
    s_lshl_b32 s76, s64, 2
    s_lshl_b32 s78, s79, 0
    s_add_u32 s76, s76, s78
    s_and_b32 s77, s65, 7
    s_mov_b32 s71, 0
    s_mov_b32 s72, 0
    s_mov_b32 s75, 0
    s_lshl_b32 s68, s66, 13
    s_add_u32 s68, s68, 131072
    s_mov_b32 s84, 0x00ff00ff
    s_mov_b32 s85, 0x00ff00ff
    s_mul_i32 s80, s65, 43
    s_lshr_b32 s80, s80, 8
    s_mul_i32 s81, s80, 6
    s_sub_u32 s81, s65, s81
    s_lshl_b32 s86, s81, 9
    s_lshl_b32 s78, s66, 7
    s_add_u32 s86, s86, s78
    s_lshl_b32 s87, s80, 12
    s_lshl_b32 s78, s66, 10
    s_add_u32 s87, s87, s78
    s_lshl_b32 s78, s81, 7
    s_add_u32 s87, s87, s78
    s_lshl_b32 s88, s80, 12
    s_lshl_b32 s78, s66, 9
    s_add_u32 s88, s88, s78
    s_lshl_b32 s78, s81, 5
    s_add_u32 s88, s88, s78
    s_add_u32 s88, s88, 16384
    s_lshl_b32 s89, s80, 6
    s_lshl_b32 s78, s81, 3
    s_add_u32 s89, s89, s78
    s_add_u32 s89, s89, 53248
    s_mul_i32 s92, s81, 786432
    s_mul_i32 s78, s66, 196608
    s_add_u32 s92, s92, s78
    s_lshl_b32 s78, s64, 10
    s_add_u32 s92, s92, s78
    s_lshl_b32 s78, s80, 8
    s_add_u32 s92, s92, s78
    s_cmp_eq_u32 s66, 0
    s_cselect_b32 s89, s89, 1073741824
    s_cmp_lt_u32 s65, 24
    s_cselect_b32 s87, s87, 1073741824
    s_cselect_b32 s89, s89, 1073741824
    s_cselect_b32 s92, s92, 1073741824
    s_lshl_b32 s90, s79, 12
    s_lshl_b32 s78, s66, 10
    s_add_u32 s90, s90, s78
    s_lshl_b32 s91, s79, 6
    s_add_u32 s91, s91, 53248
    s_lshl_b32 s95, s77, 19
    s_lshl_b32 s78, s76, 8
    s_add_u32 s95, s95, s78
    s_lshl_b32 s78, s66, 6
    s_add_u32 s95, s95, s78
    s_lshl_b32 s94, s65, 17
    s_lshl_b32 s78, s64, 10
    s_add_u32 s94, s94, s78
    s_lshl_b32 s78, s66, 8
    s_add_u32 s94, s94, s78
    s_mul_i32 s93, s64, 589824
    s_mul_i32 s78, s66, 147456
    s_add_u32 s93, s93, s78
    s_mul_i32 s78, s65, 48
    s_add_u32 s93, s93, s78
    s_mul_i32 s96, s64, 3072
    s_lshl_b32 s78, s65, 7
    s_add_u32 s96, s96, s78
    s_cmp_lt_u32 s65, 24
    s_cselect_b32 s93, s93, 1073741824
    s_cselect_b32 s74, 1, 0
    s_cmp_eq_u32 s66, 3
    s_cselect_b32 s74, s74, 0
    s_mul_i32 s78, s74, 3
    s_cmp_eq_u32 s64, 0
    s_cselect_b32 s74, s78, s74
    v_mov_b32 v7, 0
    v_and_b32 v14, 1, v0
    v_mul_u32_u24 v1, 0xaaaa, v14
    v_add_u32 v1, 0x4444, v1
    v_lshrrev_b32 v12, 4, v0
    v_and_b32 v13, 15, v0
    v_lshrrev_b32 v15, 2, v13
    v_lshrrev_b32 v17, 1, v15
    v_xor_b32 v16, v15, v17
    v_and_b32 v16, 1, v16
    v_lshl_or_b32 v16, v16, 3, v17
    v_and_b32 v17, 3, v13
    v_lshlrev_b32 v18, 1, v17
    v_xor_b32 v16, v16, v18
    v_xor_b32 v16, v16, v12
    v_lshlrev_b32 v16, 4, v16
    v_lshl_or_b32 v3, v13, 8, v16
    v_add_u32 v3, s69, v3
    v_lshrrev_b32 v18, 1, v12
    v_xor_b32 v16, v12, v18
    v_and_b32 v16, 1, v16
    v_lshl_or_b32 v16, v16, 3, v18
    v_lshlrev_b32 v18, 1, v15
    v_xor_b32 v16, v16, v18
    v_lshrrev_b32 v18, 1, v17
    v_xor_b32 v16, v16, v18
    v_lshlrev_b32 v16, 4, v16
    v_lshrrev_b32 v18, 2, v0
    v_lshl_or_b32 v16, v18, 8, v16
    v_lshl_or_b32 v2, v14, 3, v16
    v_add_u32 v2, s69, v2
    s_waitcnt lgkmcnt(0)
    s_lshl_b32 s78, s64, 17
    s_add_u32 s52, s48, s78
    s_addc_u32 s53, s49, 0
    s_add_u32 s56, s48, 1048576
    s_addc_u32 s57, s49, 0
    v_lshrrev_b32 v57, 4, v0
    v_lshlrev_b32 v56, 5, v57
    v_xor_b32 v56, v56, v6
    s_lshl_b32 s79, s66, 7
    v_xor_b32 v56, s79, v56
    v_and_b32 v56, 0xf0, v56
    v_lshl_or_b32 v56, v57, 13, v56
    s_add_u32 m0, s68, 0
    s_add_u32 s79, s92, 0
    buffer_load_dwordx4 v56, s[24:27], s79 offen offset:0  lds
    s_add_u32 s79, s92, 31744
    buffer_load_dwordx4 v56, s[24:27], s79 offen offset:1024  lds
    s_add_u32 s79, s92, 63488
    buffer_load_dwordx4 v56, s[24:27], s79 offen offset:2048  lds
    s_add_u32 m0, s68, 3072
    s_add_u32 s79, s92, 98304
    buffer_load_dwordx4 v56, s[24:27], s79 offen offset:0  lds
    s_add_u32 s79, s92, 130048
    buffer_load_dwordx4 v56, s[24:27], s79 offen offset:1024  lds
    s_add_u32 s79, s92, 161792
    buffer_load_dwordx4 v56, s[24:27], s79 offen offset:2048  lds
    v_mov_b32 v53, 0x3f803f80
    s_lshl_b64 s[82:83], s[84:85], 8
    v_cndmask_b32 v16, 0, v53, s[82:83]
    v_mov_b32 v17, v16
    v_mov_b64 v[18:19], v[16:17]
    v_mov_b64 v[20:21], v[16:17]
    v_mov_b64 v[22:23], v[16:17]
    v_mov_b64 v[24:25], v[16:17]
    v_mov_b64 v[26:27], v[16:17]
    s_mul_i32 s78, s81, 192
    v_mul_u32_u24 v58, 3, v0
    s_mov_b32 exec_lo, 0x00010001
    s_mov_b32 exec_hi, 0x00010001
    buffer_load_dwordx4 v[16:19], v58, s[20:23], s78 offen offset:0
    buffer_load_dwordx4 v[20:23], v58, s[20:23], s78 offen offset:16
    buffer_load_dwordx4 v[24:27], v58, s[20:23], s78 offen offset:32
    s_mov_b64 exec, -1
    v_lshlrev_b32 v58, 2, v0
    s_mul_i32 s78, s65, 48
    s_cmp_eq_u32 s74, 3
    s_cselect_b32 s78, s78, 1073741824
    buffer_load_dword v5, v58, s[20:23], s78 offen
    v_mov_b32 v56, -1
    v_mov_b32 v57, -1
    v_mov_b32 v58, -1
    v_mov_b32 v59, -1
    s_lshl_b32 s82, s64, 17
    s_mul_i32 s78, s65, 2560
    s_add_u32 s82, s82, s78
    s_mul_i32 s78, s66, 640
    s_add_u32 s82, s82, s78
    s_mul_i32 s79, s64, 49152
    s_mul_i32 s78, s65, 1536
    s_add_u32 s79, s79, s78
    s_mul_i32 s78, s66, 384
    s_add_u32 s79, s79, s78
    s_add_u32 s79, s79, 1048576
    s_mov_b32 exec_hi, 0xff
    buffer_store_dwordx4 v[56:59], v6, s[48:51], s82 offen sc1
    s_mov_b64 exec, 16777215
    buffer_store_dwordx4 v[56:59], v6, s[48:51], s79 offen sc1
    s_mov_b64 exec, -1
    v_xor_b32 v12, 0, v3
    v_xor_b32 v13, 64, v3
    v_xor_b32 v14, 128, v3
    v_xor_b32 v15, 192, v3
    s_waitcnt vmcnt(17)
    s_add_u32 m0, s69, 4096
    s_add_u32 s78, s70, 16384
    buffer_load_dwordx4 v10, s[4:7], s78 offen offset:2048 nt lds
    s_waitcnt vmcnt(17)
    s_add_u32 m0, s69, 4096
    s_add_u32 s78, s70, 16384
    buffer_load_dwordx4 v11, s[4:7], s78 offen offset:3072 nt lds
    s_waitcnt vmcnt(17)
    s_add_u32 m0, s69, 8192
    s_add_u32 s78, s70, 32768
    buffer_load_dwordx4 v8, s[4:7], s78 offen offset:0 nt lds
    s_waitcnt vmcnt(17)
    s_add_u32 m0, s69, 8192
    s_add_u32 s78, s70, 32768
    buffer_load_dwordx4 v9, s[4:7], s78 offen offset:1024 nt lds
    ds_read_b128 a[0:3], v12 offset:0
    ds_read_b128 a[4:7], v13 offset:0
    ds_read_b128 a[8:11], v14 offset:0
    ds_read_b128 a[12:15], v15 offset:0
    s_waitcnt lgkmcnt(0)
    s_waitcnt vmcnt(17)
    s_add_u32 m0, s69, 8192
    s_add_u32 s78, s70, 32768
    buffer_load_dwordx4 v10, s[4:7], s78 offen offset:2048 nt lds
    s_waitcnt vmcnt(17)
    s_add_u32 m0, s69, 8192
    s_add_u32 s78, s70, 32768
    buffer_load_dwordx4 v11, s[4:7], s78 offen offset:3072 nt lds
    s_waitcnt vmcnt(5)
    s_add_u32 m0, s69, 12288
    s_add_u32 s78, s70, 49152
    buffer_load_dwordx4 v8, s[4:7], s78 offen offset:0 nt lds
    s_waitcnt vmcnt(5)
    s_add_u32 m0, s69, 12288
    s_add_u32 s78, s70, 49152
    buffer_load_dwordx4 v9, s[4:7], s78 offen offset:1024 nt lds
    ds_read_b128 a[16:19], v12 offset:4096
    ds_read_b128 a[20:23], v13 offset:4096
    ds_read_b128 a[24:27], v14 offset:4096
    ds_read_b128 a[28:31], v15 offset:4096
    s_waitcnt lgkmcnt(0)
    s_waitcnt vmcnt(5)
    s_add_u32 m0, s69, 12288
    s_add_u32 s78, s70, 49152
    buffer_load_dwordx4 v10, s[4:7], s78 offen offset:2048 nt lds
    s_waitcnt vmcnt(5)
    s_add_u32 m0, s69, 12288
    s_add_u32 s78, s70, 49152
    buffer_load_dwordx4 v11, s[4:7], s78 offen offset:3072 nt lds
    s_waitcnt vmcnt(5)
    s_add_u32 m0, s69, 0
    s_add_u32 s78, s70, 65536
    buffer_load_dwordx4 v8, s[4:7], s78 offen offset:0 nt lds
    s_waitcnt vmcnt(5)
    s_add_u32 m0, s69, 0
    s_add_u32 s78, s70, 65536
    buffer_load_dwordx4 v9, s[4:7], s78 offen offset:1024 nt lds
    ds_read_b128 a[32:35], v12 offset:8192
    ds_read_b128 a[36:39], v13 offset:8192
    ds_read_b128 a[40:43], v14 offset:8192
    ds_read_b128 a[44:47], v15 offset:8192
    s_waitcnt lgkmcnt(0)
    v_lshrrev_b32 v254, 4, v0
    v_mul_u32_u24 v254, 768, v254
    s_lshr_b32 s80, s65, 1
    s_lshl_b32 s1, s64, 20
    s_lshl_b32 s78, s80, 16
    s_add_u32 s1, s1, s78
    s_lshl_b32 s78, s66, 8
    s_add_u32 s1, s1, s78
    v_add_u32 v246, 0, v0
    v_mul_u32_u24 v246, 21846, v246
    v_lshrrev_b32 v246, 16, v246
    v_mul_u32_u24 v246, 1104, v246
    v_lshl_add_u32 v246, v0, 4, v246
    v_add_u32 v247, 64, v0
    v_mul_u32_u24 v247, 21846, v247
    v_lshrrev_b32 v247, 16, v247
    v_mul_u32_u24 v247, 1104, v247
    v_lshl_add_u32 v247, v0, 4, v247
    v_add_u32 v255, 128, v0
    v_mul_u32_u24 v255, 21846, v255
    v_lshrrev_b32 v255, 16, v255
    v_mul_u32_u24 v255, 1104, v255
    v_lshl_add_u32 v255, v0, 4, v255
    s_waitcnt vmcnt(5)
    s_add_u32 m0, s69, 0
    s_add_u32 s78, s70, 65536
    buffer_load_dwordx4 v10, s[4:7], s78 offen offset:2048 nt lds
    s_waitcnt vmcnt(5)
    s_add_u32 m0, s69, 0
    s_add_u32 s78, s70, 65536
    buffer_load_dwordx4 v11, s[4:7], s78 offen offset:3072 nt lds
    s_waitcnt vmcnt(5)
    s_add_u32 m0, s69, 4096
    s_add_u32 s78, s70, 81920
    buffer_load_dwordx4 v8, s[4:7], s78 offen offset:0 nt lds
    s_waitcnt vmcnt(5)
    s_add_u32 m0, s69, 4096
    s_add_u32 s78, s70, 81920
    buffer_load_dwordx4 v9, s[4:7], s78 offen offset:1024 nt lds
    ds_read_b128 a[48:51], v12 offset:12288
    ds_read_b128 a[52:55], v13 offset:12288
    ds_read_b128 a[56:59], v14 offset:12288
    ds_read_b128 a[60:63], v15 offset:12288
    s_waitcnt lgkmcnt(0)
    s_waitcnt vmcnt(5)
    s_add_u32 m0, s69, 4096
    s_add_u32 s78, s70, 81920
    buffer_load_dwordx4 v10, s[4:7], s78 offen offset:2048 nt lds
    s_waitcnt vmcnt(5)
    s_add_u32 m0, s69, 4096
    s_add_u32 s78, s70, 81920
    buffer_load_dwordx4 v11, s[4:7], s78 offen offset:3072 nt lds
    s_waitcnt vmcnt(5)
    s_add_u32 m0, s69, 8192
    s_add_u32 s78, s70, 98304
    buffer_load_dwordx4 v8, s[4:7], s78 offen offset:0 nt lds
    s_waitcnt vmcnt(5)
    s_add_u32 m0, s69, 8192
    s_add_u32 s78, s70, 98304
    buffer_load_dwordx4 v9, s[4:7], s78 offen offset:1024 nt lds
    ds_read_b128 a[64:67], v12 offset:0
    ds_read_b128 a[68:71], v13 offset:0
    ds_read_b128 a[72:75], v14 offset:0
    ds_read_b128 a[76:79], v15 offset:0
    s_waitcnt lgkmcnt(0)
    s_waitcnt vmcnt(20)
    v_lshlrev_b32 v230, 7, v0
    s_mov_b64 exec, 31
    buffer_load_dword v239, v230, s[48:51], s82 offen
    s_mov_b64 exec, -1
    v_lshlrev_b32 v4, 16, v5
    v_and_b32 v5, 0xffff0000, v5
    s_barrier
    s_cmp_lg_u32 s66, 1
    s_cbranch_scc1 L_notw_1
    s_getreg_b32 s82, hwreg(HW_REG_XCC_ID, 0, 3)
    s_lshl_b32 s82, s82, 3
    s_lshl_b64 s[82:83], 1, s82
    v_mov_b32 v222, s82
    v_mov_b32 v223, s83
    s_lshl_b32 s78, s64, 5
    s_mov_b64 exec, 1
    buffer_atomic_add_x2 v[222:223], v0, s[16:19], s78 offen sc1
    s_mov_b64 exec, -1
L_notw_1:
    s_waitcnt vmcnt(6)
    s_add_u32 m0, s69, 8192
    s_add_u32 s78, s70, 98304
    buffer_load_dwordx4 v10, s[4:7], s78 offen offset:2048 nt lds
    s_waitcnt vmcnt(6)
    s_add_u32 m0, s69, 8192
    s_add_u32 s78, s70, 98304
    buffer_load_dwordx4 v11, s[4:7], s78 offen offset:3072 nt lds
    s_waitcnt vmcnt(6)
    s_add_u32 m0, s69, 12288
    s_add_u32 s78, s70, 114688
    buffer_load_dwordx4 v8, s[4:7], s78 offen offset:0 nt lds
    s_waitcnt vmcnt(6)
    s_add_u32 m0, s69, 12288
    s_add_u32 s78, s70, 114688
    buffer_load_dwordx4 v9, s[4:7], s78 offen offset:1024 nt lds
    ds_read_b128 a[80:83], v12 offset:4096
    ds_read_b128 a[84:87], v13 offset:4096
    ds_read_b128 a[88:91], v14 offset:4096
    ds_read_b128 a[92:95], v15 offset:4096
    s_waitcnt lgkmcnt(0)
    s_waitcnt vmcnt(6)
    s_add_u32 m0, s69, 12288
    s_add_u32 s78, s70, 114688
    buffer_load_dwordx4 v10, s[4:7], s78 offen offset:2048 nt lds
    s_waitcnt vmcnt(6)
    s_add_u32 m0, s69, 12288
    s_add_u32 s78, s70, 114688
    buffer_load_dwordx4 v11, s[4:7], s78 offen offset:3072 nt lds
    s_waitcnt vmcnt(5)
    s_add_u32 m0, s69, 0
    s_add_u32 s78, s70, 131072
    buffer_load_dwordx4 v8, s[4:7], s78 offen offset:0 nt lds
    s_waitcnt vmcnt(5)
    s_add_u32 m0, s69, 0
    s_add_u32 s78, s70, 131072
    buffer_load_dwordx4 v9, s[4:7], s78 offen offset:1024 nt lds
    ds_read_b128 a[96:99], v12 offset:8192
    ds_read_b128 a[100:103], v13 offset:8192
    ds_read_b128 a[104:107], v14 offset:8192
    ds_read_b128 a[108:111], v15 offset:8192
    s_waitcnt lgkmcnt(0)
    s_waitcnt vmcnt(5)
    s_add_u32 m0, s69, 0
    s_add_u32 s78, s70, 131072
    buffer_load_dwordx4 v10, s[4:7], s78 offen offset:2048 nt lds
    s_waitcnt vmcnt(5)
    s_add_u32 m0, s69, 0
    s_add_u32 s78, s70, 131072
    buffer_load_dwordx4 v11, s[4:7], s78 offen offset:3072 nt lds
    s_waitcnt vmcnt(5)
    s_add_u32 m0, s69, 4096
    s_add_u32 s78, s70, 147456
    buffer_load_dwordx4 v8, s[4:7], s78 offen offset:0 nt lds
    s_waitcnt vmcnt(5)
    s_add_u32 m0, s69, 4096
    s_add_u32 s78, s70, 147456
    buffer_load_dwordx4 v9, s[4:7], s78 offen offset:1024 nt lds
    ds_read_b128 a[112:115], v12 offset:12288
    ds_read_b128 a[116:119], v13 offset:12288
    ds_read_b128 a[120:123], v14 offset:12288
    ds_read_b128 a[124:127], v15 offset:12288
    s_waitcnt lgkmcnt(0)
    s_waitcnt vmcnt(5)
    s_add_u32 m0, s69, 4096
    s_add_u32 s78, s70, 147456
    buffer_load_dwordx4 v10, s[4:7], s78 offen offset:2048 nt lds
    s_waitcnt vmcnt(5)
    s_add_u32 m0, s69, 4096
    s_add_u32 s78, s70, 147456
    buffer_load_dwordx4 v11, s[4:7], s78 offen offset:3072 nt lds
    s_waitcnt vmcnt(5)
    s_add_u32 m0, s69, 8192
    s_add_u32 s78, s70, 163840
    buffer_load_dwordx4 v8, s[4:7], s78 offen offset:0 nt lds
    s_waitcnt vmcnt(5)
    s_add_u32 m0, s69, 8192
    s_add_u32 s78, s70, 163840
    buffer_load_dwordx4 v9, s[4:7], s78 offen offset:1024 nt lds
    ds_read_b128 a[128:131], v12 offset:0
    ds_read_b128 a[132:135], v13 offset:0
    ds_read_b128 a[136:139], v14 offset:0
    ds_read_b128 a[140:143], v15 offset:0
    s_waitcnt lgkmcnt(0)
    s_waitcnt vmcnt(5)
    s_add_u32 m0, s69, 8192
    s_add_u32 s78, s70, 163840
    buffer_load_dwordx4 v10, s[4:7], s78 offen offset:2048 nt lds
    s_waitcnt vmcnt(5)
    s_add_u32 m0, s69, 8192
    s_add_u32 s78, s70, 163840
    buffer_load_dwordx4 v11, s[4:7], s78 offen offset:3072 nt lds
    s_waitcnt vmcnt(5)
    s_add_u32 m0, s69, 12288
    s_add_u32 s78, s70, 180224
    buffer_load_dwordx4 v8, s[4:7], s78 offen offset:0 nt lds
    s_waitcnt vmcnt(5)
    s_add_u32 m0, s69, 12288
    s_add_u32 s78, s70, 180224
    buffer_load_dwordx4 v9, s[4:7], s78 offen offset:1024 nt lds
    ds_read_b128 a[144:147], v12 offset:4096
    ds_read_b128 a[148:151], v13 offset:4096
    ds_read_b128 a[152:155], v14 offset:4096
    ds_read_b128 a[156:159], v15 offset:4096
    s_waitcnt lgkmcnt(0)
    s_waitcnt vmcnt(41)
    v_lshrrev_b32 v52, 4, v0
    v_bfe_u32 v53, v0, 2, 2
    v_lshl_add_u32 v52, v52, 5, v53
    v_and_b32 v53, 31, v0
    v_lshlrev_b32 v53, 3, v53
    v_lshl_or_b32 v52, v52, 8, v53
    s_lshl_b32 s78, s66, 6
    s_add_u32 s78, s78, 131072
    v_xor_b32 v52, s78, v52
    v_xor_b32 v54, 32, v52
    s_waitcnt vmcnt(47)
    s_barrier
    ds_read_b64_tr_b16 v[28:29], v52 offset:0
    ds_read_b64_tr_b16 v[30:31], v52 offset:1024
    ds_read_b64_tr_b16 v[32:33], v54 offset:0
    ds_read_b64_tr_b16 v[34:35], v54 offset:1024
    ds_read_b64_tr_b16 v[36:37], v52 offset:2048
    ds_read_b64_tr_b16 v[38:39], v52 offset:3072
    ds_read_b64_tr_b16 v[40:41], v54 offset:2048
    ds_read_b64_tr_b16 v[42:43], v54 offset:3072
    ds_read_b64_tr_b16 v[44:45], v52 offset:4096
    ds_read_b64_tr_b16 v[46:47], v52 offset:5120
    ds_read_b64_tr_b16 v[48:49], v54 offset:4096
    ds_read_b64_tr_b16 v[50:51], v54 offset:5120
    s_waitcnt lgkmcnt(0)
    s_barrier
    v_mfma_f32_16x16x32_bf16 v[60:63], v[16:19], v[16:19], 0
    v_mfma_f32_16x16x32_bf16 v[52:55], v[16:19], v[28:31], 0
    v_mfma_f32_16x16x32_bf16 v[56:59], v[16:19], v[32:35], 0
    v_mfma_f32_16x16x32_bf16 v[60:63], v[20:23], v[20:23], v[60:63]
    v_mfma_f32_16x16x32_bf16 v[52:55], v[20:23], v[36:39], v[52:55]
    v_mfma_f32_16x16x32_bf16 v[56:59], v[20:23], v[40:43], v[56:59]
    v_mfma_f32_16x16x32_bf16 v[60:63], v[24:27], v[24:27], v[60:63]
    v_mfma_f32_16x16x32_bf16 v[52:55], v[24:27], v[44:47], v[52:55]
    v_mfma_f32_16x16x32_bf16 v[56:59], v[24:27], v[48:51], v[56:59]
    s_nop 5
    v_pk_add_f32 v[60:61], v[60:61], v[62:63]
    v_add_f32 v60, v60, v61
    v_pk_add_f32 v[52:53], v[52:53], v[54:55]
    v_mov_b32 v61, v60
    v_pk_add_f32 v[56:57], v[56:57], v[58:59]
    v_add_f32 v52, v52, v53
    v_permlane16_swap_b32 v60, v61
    v_add_f32 v56, v56, v57
    v_add_f32 v60, v60, v61
    s_nop 0
    v_permlane16_swap_b32 v52, v56
    v_add_f32_dpp v60, v60, v60 quad_perm:[1,0,3,2] row_mask:0xf bank_mask:0xf
    v_add_f32 v52, v52, v56
    s_cmp_eq_u32 s67, 0
    v_add_f32_dpp v60, v60, v60 quad_perm:[2,3,0,1] row_mask:0xf bank_mask:0xf
    s_nop 1
    v_add_f32_dpp v60, v60, v60 row_half_mirror row_mask:0xf bank_mask:0xf
    s_add_u32 m0, s68, 0
    s_add_u32 s78, s93, 0
    buffer_load_dwordx4 v246, s[28:31], s78 offen offset:0 lds
    s_add_u32 m0, s68, 0
    s_add_u32 s78, s93, 0
    buffer_load_dwordx4 v247, s[28:31], s78 offen offset:1024 lds
    s_add_u32 m0, s68, 0
    s_add_u32 s78, s93, 0
    buffer_load_dwordx4 v255, s[28:31], s78 offen offset:2048 lds
    s_add_u32 m0, s68, 3072
    s_add_u32 s78, s93, 73728
    buffer_load_dwordx4 v246, s[28:31], s78 offen offset:0 lds
    s_add_u32 m0, s68, 3072
    s_add_u32 s78, s93, 73728
    buffer_load_dwordx4 v247, s[28:31], s78 offen offset:1024 lds
    s_add_u32 m0, s68, 3072
    s_add_u32 s78, s93, 73728
    buffer_load_dwordx4 v255, s[28:31], s78 offen offset:2048 lds
    s_waitcnt vmcnt(11)
    s_add_u32 m0, s69, 12288
    s_add_u32 s78, s70, 180224
    buffer_load_dwordx4 v10, s[4:7], s78 offen offset:2048 nt lds
    s_waitcnt vmcnt(11)
    s_add_u32 m0, s69, 12288
    s_add_u32 s78, s70, 180224
    buffer_load_dwordx4 v11, s[4:7], s78 offen offset:3072 nt lds
    s_waitcnt vmcnt(11)
    s_add_u32 m0, s69, 0
    s_add_u32 s78, s70, 196608
    buffer_load_dwordx4 v8, s[4:7], s78 offen offset:0 nt lds
    s_waitcnt vmcnt(11)
    s_add_u32 m0, s69, 0
    s_add_u32 s78, s70, 196608
    buffer_load_dwordx4 v9, s[4:7], s78 offen offset:1024 nt lds
    ds_read_b128 a[160:163], v12 offset:8192
    ds_read_b128 a[164:167], v13 offset:8192
    ds_read_b128 a[168:171], v14 offset:8192
    ds_read_b128 a[172:175], v15 offset:8192
    s_waitcnt lgkmcnt(0)
    s_add_u32 m0, s69, 65536
    v_add_u32 v238, v8, v254
    s_add_u32 s78, s1, 0
    buffer_load_dwordx4 v238, s[12:15], s78 offen nt lds
    s_add_u32 m0, s69, 66560
    v_add_u32 v238, v9, v254
    s_add_u32 s78, s1, 4096
    buffer_load_dwordx4 v238, s[12:15], s78 offen nt lds
    s_add_u32 m0, s69, 67584
    v_add_u32 v238, v10, v254
    s_add_u32 s78, s1, 8192
    buffer_load_dwordx4 v238, s[12:15], s78 offen nt lds
    s_add_u32 m0, s69, 68608
    v_add_u32 v238, v11, v254
    s_add_u32 s78, s1, 12288
    buffer_load_dwordx4 v238, s[12:15], s78 offen nt lds
    s_waitcnt vmcnt(15)
    s_add_u32 m0, s69, 0
    s_add_u32 s78, s70, 196608
    buffer_load_dwordx4 v10, s[4:7], s78 offen offset:2048 nt lds
    s_waitcnt vmcnt(15)
    s_add_u32 m0, s69, 0
    s_add_u32 s78, s70, 196608
    buffer_load_dwordx4 v11, s[4:7], s78 offen offset:3072 nt lds
    s_waitcnt vmcnt(9)
    s_add_u32 m0, s69, 4096
    s_add_u32 s78, s70, 212992
    buffer_load_dwordx4 v8, s[4:7], s78 offen offset:0 nt lds
    s_waitcnt vmcnt(9)
    s_add_u32 m0, s69, 4096
    s_add_u32 s78, s70, 212992
    buffer_load_dwordx4 v9, s[4:7], s78 offen offset:1024 nt lds
    ds_read_b128 a[176:179], v12 offset:12288
    ds_read_b128 a[180:183], v13 offset:12288
    ds_read_b128 a[184:187], v14 offset:12288
    ds_read_b128 a[188:191], v15 offset:12288
    s_waitcnt lgkmcnt(0)
    s_add_u32 m0, s69, 69632
    v_add_u32 v238, v8, v254
    s_add_u32 s78, s1, 16384
    buffer_load_dwordx4 v238, s[12:15], s78 offen nt lds
    s_add_u32 m0, s69, 70656
    v_add_u32 v238, v9, v254
    s_add_u32 s78, s1, 20480
    buffer_load_dwordx4 v238, s[12:15], s78 offen nt lds
    s_add_u32 m0, s69, 71680
    v_add_u32 v238, v10, v254
    s_add_u32 s78, s1, 24576
    buffer_load_dwordx4 v238, s[12:15], s78 offen nt lds
    s_add_u32 m0, s69, 72704
    v_add_u32 v238, v11, v254
    s_add_u32 s78, s1, 28672
    buffer_load_dwordx4 v238, s[12:15], s78 offen nt lds
    s_waitcnt vmcnt(13)
    s_add_u32 m0, s69, 4096
    s_add_u32 s78, s70, 212992
    buffer_load_dwordx4 v10, s[4:7], s78 offen offset:2048 nt lds
    s_waitcnt vmcnt(13)
    s_add_u32 m0, s69, 4096
    s_add_u32 s78, s70, 212992
    buffer_load_dwordx4 v11, s[4:7], s78 offen offset:3072 nt lds
    s_waitcnt vmcnt(9)
    s_add_u32 m0, s69, 8192
    s_add_u32 s78, s70, 229376
    buffer_load_dwordx4 v8, s[4:7], s78 offen offset:0 nt lds
    s_waitcnt vmcnt(9)
    s_add_u32 m0, s69, 8192
    s_add_u32 s78, s70, 229376
    buffer_load_dwordx4 v9, s[4:7], s78 offen offset:1024 nt lds
    ds_read_b128 a[192:195], v12 offset:0
    ds_read_b128 a[196:199], v13 offset:0
    ds_read_b128 a[200:203], v14 offset:0
    ds_read_b128 a[204:207], v15 offset:0
    s_waitcnt lgkmcnt(0)
    v_and_b32 v57, 7, v0
    v_lshlrev_b32 v57, 5, v57
    buffer_load_dwordx2 v[58:59], v57, s[16:19], 0 offen sc1
    s_add_u32 m0, s69, 73728
    v_add_u32 v238, v8, v254
    s_add_u32 s78, s1, 32768
    s_mov_b64 exec, s[84:85]
    buffer_load_dwordx4 v238, s[12:15], s78 offen nt lds
    s_mov_b64 exec, -1
    s_add_u32 m0, s69, 74752
    v_add_u32 v238, v9, v254
    s_add_u32 s78, s1, 36864
    s_not_b64 exec, s[84:85]
    buffer_load_dwordx4 v238, s[12:15], s78 offen nt lds
    s_mov_b64 exec, -1
    s_add_u32 m0, s69, 75776
    v_add_u32 v238, v10, v254
    s_add_u32 s78, s1, 40960
    s_not_b64 exec, s[84:85]
    buffer_load_dwordx4 v238, s[12:15], s78 offen nt lds
    s_mov_b64 exec, -1
    s_add_u32 m0, s69, 76800
    v_add_u32 v238, v11, v254
    s_add_u32 s78, s1, 45056
    s_mov_b64 exec, s[84:85]
    buffer_load_dwordx4 v238, s[12:15], s78 offen nt lds
    s_mov_b64 exec, -1
    s_branch L_isl_0
L_isl_ret:
    s_waitcnt vmcnt(14)
    s_add_u32 m0, s69, 8192
    s_add_u32 s78, s70, 229376
    buffer_load_dwordx4 v10, s[4:7], s78 offen offset:2048 nt lds
    s_waitcnt vmcnt(14)
    s_add_u32 m0, s69, 8192
    s_add_u32 s78, s70, 229376
    buffer_load_dwordx4 v11, s[4:7], s78 offen offset:3072 nt lds
    s_waitcnt vmcnt(10)
    s_add_u32 m0, s69, 12288
    s_add_u32 s78, s70, 245760
    buffer_load_dwordx4 v8, s[4:7], s78 offen offset:0 nt lds
    s_waitcnt vmcnt(10)
    s_add_u32 m0, s69, 12288
    s_add_u32 s78, s70, 245760
    buffer_load_dwordx4 v9, s[4:7], s78 offen offset:1024 nt lds
    ds_read_b128 a[208:211], v12 offset:4096
    ds_read_b128 a[212:215], v13 offset:4096
    ds_read_b128 a[216:219], v14 offset:4096
    ds_read_b128 a[220:223], v15 offset:4096
    s_waitcnt lgkmcnt(0)
    s_add_u32 m0, s69, 77824
    v_add_u32 v238, v8, v254
    s_add_u32 s78, s1, 49152
    s_mov_b64 exec, s[84:85]
    buffer_load_dwordx4 v238, s[12:15], s78 offen nt lds
    s_mov_b64 exec, -1
    s_add_u32 m0, s69, 78848
    v_add_u32 v238, v9, v254
    s_add_u32 s78, s1, 53248
    s_not_b64 exec, s[84:85]
    buffer_load_dwordx4 v238, s[12:15], s78 offen nt lds
    s_mov_b64 exec, -1
    s_add_u32 m0, s69, 79872
    v_add_u32 v238, v10, v254
    s_add_u32 s78, s1, 57344
    s_not_b64 exec, s[84:85]
    buffer_load_dwordx4 v238, s[12:15], s78 offen nt lds
    s_mov_b64 exec, -1
    s_add_u32 m0, s69, 80896
    v_add_u32 v238, v11, v254
    s_add_u32 s78, s1, 61440
    s_mov_b64 exec, s[84:85]
    buffer_load_dwordx4 v238, s[12:15], s78 offen nt lds
    s_mov_b64 exec, -1
    s_waitcnt vmcnt(14)
    s_add_u32 m0, s69, 12288
    s_add_u32 s78, s70, 245760
    buffer_load_dwordx4 v10, s[4:7], s78 offen offset:2048 nt lds
    s_waitcnt vmcnt(14)
    s_add_u32 m0, s69, 12288
    s_add_u32 s78, s70, 245760
    buffer_load_dwordx4 v11, s[4:7], s78 offen offset:3072 nt lds
    s_waitcnt vmcnt(9)
    s_add_u32 m0, s69, 0
    s_add_u32 s78, s70, 0
    buffer_load_dwordx4 v8, s[8:11], s78 offen offset:0 nt lds
    s_waitcnt vmcnt(9)
    s_add_u32 m0, s69, 0
    s_add_u32 s78, s70, 0
    buffer_load_dwordx4 v9, s[8:11], s78 offen offset:1024 nt lds
    ds_read_b128 a[224:227], v12 offset:8192
    ds_read_b128 a[228:231], v13 offset:8192
    ds_read_b128 a[232:235], v14 offset:8192
    ds_read_b128 a[236:239], v15 offset:8192
    s_waitcnt lgkmcnt(0)
    s_waitcnt vmcnt(9)
    s_add_u32 m0, s69, 0
    s_add_u32 s78, s70, 0
    buffer_load_dwordx4 v10, s[8:11], s78 offen offset:2048 nt lds
    s_waitcnt vmcnt(9)
    s_add_u32 m0, s69, 0
    s_add_u32 s78, s70, 0
    buffer_load_dwordx4 v11, s[8:11], s78 offen offset:3072 nt lds
    s_waitcnt vmcnt(5)
    s_add_u32 m0, s69, 4096
    s_add_u32 s78, s70, 16384
    buffer_load_dwordx4 v8, s[8:11], s78 offen offset:0 nt lds
    s_waitcnt vmcnt(5)
    s_add_u32 m0, s69, 4096
    s_add_u32 s78, s70, 16384
    buffer_load_dwordx4 v9, s[8:11], s78 offen offset:1024 nt lds
    ds_read_b128 a[240:243], v12 offset:12288
    ds_read_b128 a[244:247], v13 offset:12288
    ds_read_b128 a[248:251], v14 offset:12288
    ds_read_b128 a[252:255], v15 offset:12288
    s_waitcnt lgkmcnt(0)
    s_waitcnt vmcnt(20)
L_chk_2:
    v_sad_u8 v61, v58, 0, 0
    v_sad_u8 v61, v59, 0, v61
    v_cmp_ne_u32 vcc, 32, v61
    s_cbranch_vccnz L_cretry_3
L_cdone_4:
    s_getreg_b32 s82, hwreg(HW_REG_XCC_ID, 0, 3)
    s_lshl_b32 s82, s82, 3
    s_lshl_b64 s[82:83], 32, s82
    v_readlane_b32 s80, v58, s64
    v_readlane_b32 s81, v59, s64
    s_nop 0
    s_cmp_eq_u64 s[82:83], s[80:81]
    s_cselect_b32 s67, 1, 0
    v_and_b32 v14, 31, v0
    v_lshlrev_b32 v14, 2, v14
    v_lshrrev_b32 v15, 5, v0
    v_mul_u32_u24 v15, 57344, v15
    v_add_u32 v14, v14, v15
    v_lshrrev_b32 v15, 1, v0
    s_mov_b32 vcc_lo, 4294967038
    s_mov_b32 vcc_hi, 4294967295
    v_cndmask_b32 v15, v15, 2.0, vcc
    s_cmp_eq_u32 s67, 0
    s_cbranch_scc1 L_slow_5
    buffer_store_dword v52, v14, s[52:55], s87 offen
    buffer_store_dword v60, v15, s[52:55], s89 offen offset:0
L_back_6:
    s_waitcnt vmcnt(7)
    s_add_u32 m0, s69, 4096
    s_add_u32 s78, s70, 16384
    buffer_load_dwordx4 v10, s[8:11], s78 offen offset:2048 nt lds
    s_waitcnt vmcnt(7)
    s_add_u32 m0, s69, 4096
    s_add_u32 s78, s70, 16384
    buffer_load_dwordx4 v11, s[8:11], s78 offen offset:3072 nt lds
    s_waitcnt vmcnt(7)
    s_add_u32 m0, s69, 8192
    s_add_u32 s78, s70, 32768
    buffer_load_dwordx4 v8, s[8:11], s78 offen offset:0 nt lds
    s_waitcnt vmcnt(7)
    s_add_u32 m0, s69, 8192
    s_add_u32 s78, s70, 32768
    buffer_load_dwordx4 v9, s[8:11], s78 offen offset:1024 nt lds
    v_xor_b32 v12, 0, v2
    v_xor_b32 v13, 32, v2
    v_xor_b32 v14, 64, v2
    v_xor_b32 v15, 96, v2
    v_xor_b32 v16, 128, v2
    v_xor_b32 v17, 160, v2
    v_xor_b32 v18, 192, v2
    v_xor_b32 v19, 224, v2
    ds_read_b64_tr_b16 v[64:65], v12 offset:0
    ds_read_b64_tr_b16 v[72:73], v13 offset:0
    ds_read_b64_tr_b16 v[80:81], v14 offset:0
    ds_read_b64_tr_b16 v[88:89], v15 offset:0
    ds_read_b64_tr_b16 v[96:97], v16 offset:0
    ds_read_b64_tr_b16 v[104:105], v17 offset:0
    ds_read_b64_tr_b16 v[112:113], v18 offset:0
    ds_read_b64_tr_b16 v[120:121], v19 offset:0
    s_waitcnt lgkmcnt(0)
    s_waitcnt vmcnt(7)
    s_add_u32 m0, s69, 8192
    s_add_u32 s78, s70, 32768
    buffer_load_dwordx4 v10, s[8:11], s78 offen offset:2048 nt lds
    s_waitcnt vmcnt(7)
    s_add_u32 m0, s69, 8192
    s_add_u32 s78, s70, 32768
    buffer_load_dwordx4 v11, s[8:11], s78 offen offset:3072 nt lds
    s_waitcnt vmcnt(5)
    s_add_u32 m0, s69, 12288
    s_add_u32 s78, s70, 49152
    buffer_load_dwordx4 v8, s[8:11], s78 offen offset:0 nt lds
    s_waitcnt vmcnt(5)
    s_add_u32 m0, s69, 12288
    s_add_u32 s78, s70, 49152
    buffer_load_dwordx4 v9, s[8:11], s78 offen offset:1024 nt lds
    ds_read_b64_tr_b16 v[66:67], v12 offset:4096
    ds_read_b64_tr_b16 v[74:75], v13 offset:4096
    ds_read_b64_tr_b16 v[82:83], v14 offset:4096
    ds_read_b64_tr_b16 v[90:91], v15 offset:4096
    ds_read_b64_tr_b16 v[98:99], v16 offset:4096
    ds_read_b64_tr_b16 v[106:107], v17 offset:4096
    ds_read_b64_tr_b16 v[114:115], v18 offset:4096
    ds_read_b64_tr_b16 v[122:123], v19 offset:4096
    s_waitcnt lgkmcnt(0)
    s_waitcnt vmcnt(5)
    s_add_u32 m0, s69, 12288
    s_add_u32 s78, s70, 49152
    buffer_load_dwordx4 v10, s[8:11], s78 offen offset:2048 nt lds
    s_waitcnt vmcnt(5)
    s_add_u32 m0, s69, 12288
    s_add_u32 s78, s70, 49152
    buffer_load_dwordx4 v11, s[8:11], s78 offen offset:3072 nt lds
    s_waitcnt vmcnt(5)
    s_add_u32 m0, s69, 0
    s_add_u32 s78, s70, 65536
    buffer_load_dwordx4 v8, s[8:11], s78 offen offset:0 nt lds
    s_waitcnt vmcnt(5)
    s_add_u32 m0, s69, 0
    s_add_u32 s78, s70, 65536
    buffer_load_dwordx4 v9, s[8:11], s78 offen offset:1024 nt lds
    ds_read_b64_tr_b16 v[68:69], v12 offset:8192
    ds_read_b64_tr_b16 v[76:77], v13 offset:8192
    ds_read_b64_tr_b16 v[84:85], v14 offset:8192
    ds_read_b64_tr_b16 v[92:93], v15 offset:8192
    ds_read_b64_tr_b16 v[100:101], v16 offset:8192
    ds_read_b64_tr_b16 v[108:109], v17 offset:8192
    ds_read_b64_tr_b16 v[116:117], v18 offset:8192
    ds_read_b64_tr_b16 v[124:125], v19 offset:8192
    s_waitcnt lgkmcnt(0)
    v_and_b32 v48, 4, v0
    v_lshlrev_b32 v48, 3, v48
    v_and_b32 v49, 3, v0
    v_lshl_or_b32 v48, v49, 2, v48
    v_lshrrev_b32 v49, 5, v0
    v_lshl_or_b32 v48, v49, 4, v48
    v_bfe_u32 v49, v0, 4, 1
    v_lshl_or_b32 v48, v49, 1, v48
    s_lshl_b32 s78, s66, 6
    s_add_u32 s78, s78, 154624
    v_add_u32 v48, s78, v48
    v_and_b32 v49, 7, v0
    v_lshlrev_b32 v49, 3, v49
    s_mov_b32 vcc_lo, 3233857728
    s_mov_b32 vcc_hi, 3233857728
    v_cndmask_b32 v49, v49, 2.0, vcc
    s_mov_b32 vcc_lo, 0
    s_mov_b32 vcc_hi, 4294901760
    v_cndmask_b32 v51, v6, 2.0, vcc
    v_and_b32 v50, 48, v0
    v_lshlrev_b32 v50, 1, v50
    v_and_or_b32 v50, v6, 16, v50
    v_add_u32 v50, 154624, v50
    s_add_u32 s82, s90, 57344
    buffer_load_dwordx2 v[52:53], v49, s[52:55], s91 offen sc1
    buffer_load_dwordx4 v[40:43], v51, s[52:55], s90 offen sc1
    buffer_load_dwordx4 v[44:47], v51, s[52:55], s82 offen sc1
    s_waitcnt vmcnt(8)
    s_add_u32 m0, s69, 0
    s_add_u32 s78, s70, 65536
    buffer_load_dwordx4 v10, s[8:11], s78 offen offset:2048 nt lds
    s_waitcnt vmcnt(8)
    s_add_u32 m0, s69, 0
    s_add_u32 s78, s70, 65536
    buffer_load_dwordx4 v11, s[8:11], s78 offen offset:3072 nt lds
    s_waitcnt vmcnt(8)
    s_add_u32 m0, s69, 4096
    s_add_u32 s78, s70, 81920
    buffer_load_dwordx4 v8, s[8:11], s78 offen offset:0 nt lds
    s_waitcnt vmcnt(8)
    s_add_u32 m0, s69, 4096
    s_add_u32 s78, s70, 81920
    buffer_load_dwordx4 v9, s[8:11], s78 offen offset:1024 nt lds
    ds_read_b64_tr_b16 v[70:71], v12 offset:12288
    ds_read_b64_tr_b16 v[78:79], v13 offset:12288
    ds_read_b64_tr_b16 v[86:87], v14 offset:12288
    ds_read_b64_tr_b16 v[94:95], v15 offset:12288
    ds_read_b64_tr_b16 v[102:103], v16 offset:12288
    ds_read_b64_tr_b16 v[110:111], v17 offset:12288
    ds_read_b64_tr_b16 v[118:119], v18 offset:12288
    ds_read_b64_tr_b16 v[126:127], v19 offset:12288
    s_waitcnt lgkmcnt(0)
    s_waitcnt vmcnt(8)
    s_add_u32 m0, s69, 4096
    s_add_u32 s78, s70, 81920
    buffer_load_dwordx4 v10, s[8:11], s78 offen offset:2048 nt lds
    s_waitcnt vmcnt(8)
    s_add_u32 m0, s69, 4096
    s_add_u32 s78, s70, 81920
    buffer_load_dwordx4 v11, s[8:11], s78 offen offset:3072 nt lds
    s_waitcnt vmcnt(5)
    s_add_u32 m0, s69, 8192
    s_add_u32 s78, s70, 98304
    buffer_load_dwordx4 v8, s[8:11], s78 offen offset:0 nt lds
    s_waitcnt vmcnt(5)
    s_add_u32 m0, s69, 8192
    s_add_u32 s78, s70, 98304
    buffer_load_dwordx4 v9, s[8:11], s78 offen offset:1024 nt lds
    ds_read_b64_tr_b16 v[128:129], v12 offset:0
    ds_read_b64_tr_b16 v[136:137], v13 offset:0
    ds_read_b64_tr_b16 v[144:145], v14 offset:0
    ds_read_b64_tr_b16 v[152:153], v15 offset:0
    ds_read_b64_tr_b16 v[160:161], v16 offset:0
    ds_read_b64_tr_b16 v[168:169], v17 offset:0
    ds_read_b64_tr_b16 v[176:177], v18 offset:0
    ds_read_b64_tr_b16 v[184:185], v19 offset:0
    s_waitcnt lgkmcnt(0)
    s_waitcnt vmcnt(5)
    s_add_u32 m0, s69, 8192
    s_add_u32 s78, s70, 98304
    buffer_load_dwordx4 v10, s[8:11], s78 offen offset:2048 nt lds
    s_waitcnt vmcnt(5)
    s_add_u32 m0, s69, 8192
    s_add_u32 s78, s70, 98304
    buffer_load_dwordx4 v11, s[8:11], s78 offen offset:3072 nt lds
    s_waitcnt vmcnt(5)
    s_add_u32 m0, s69, 12288
    s_add_u32 s78, s70, 114688
    buffer_load_dwordx4 v8, s[8:11], s78 offen offset:0 nt lds
    s_waitcnt vmcnt(5)
    s_add_u32 m0, s69, 12288
    s_add_u32 s78, s70, 114688
    buffer_load_dwordx4 v9, s[8:11], s78 offen offset:1024 nt lds
    ds_read_b64_tr_b16 v[130:131], v12 offset:4096
    ds_read_b64_tr_b16 v[138:139], v13 offset:4096
    ds_read_b64_tr_b16 v[146:147], v14 offset:4096
    ds_read_b64_tr_b16 v[154:155], v15 offset:4096
    ds_read_b64_tr_b16 v[162:163], v16 offset:4096
    ds_read_b64_tr_b16 v[170:171], v17 offset:4096
    ds_read_b64_tr_b16 v[178:179], v18 offset:4096
    ds_read_b64_tr_b16 v[186:187], v19 offset:4096
    s_waitcnt lgkmcnt(0)
    s_waitcnt vmcnt(5)
    s_add_u32 m0, s69, 12288
    s_add_u32 s78, s70, 114688
    buffer_load_dwordx4 v10, s[8:11], s78 offen offset:2048 nt lds
    s_waitcnt vmcnt(5)
    s_add_u32 m0, s69, 12288
    s_add_u32 s78, s70, 114688
    buffer_load_dwordx4 v11, s[8:11], s78 offen offset:3072 nt lds
    s_waitcnt vmcnt(5)
    s_add_u32 m0, s69, 0
    s_add_u32 s78, s70, 131072
    buffer_load_dwordx4 v8, s[8:11], s78 offen offset:0 nt lds
    s_waitcnt vmcnt(5)
    s_add_u32 m0, s69, 0
    s_add_u32 s78, s70, 131072
    buffer_load_dwordx4 v9, s[8:11], s78 offen offset:1024 nt lds
    ds_read_b64_tr_b16 v[132:133], v12 offset:8192
    ds_read_b64_tr_b16 v[140:141], v13 offset:8192
    ds_read_b64_tr_b16 v[148:149], v14 offset:8192
    ds_read_b64_tr_b16 v[156:157], v15 offset:8192
    ds_read_b64_tr_b16 v[164:165], v16 offset:8192
    ds_read_b64_tr_b16 v[172:173], v17 offset:8192
    ds_read_b64_tr_b16 v[180:181], v18 offset:8192
    ds_read_b64_tr_b16 v[188:189], v19 offset:8192
    s_waitcnt lgkmcnt(0)
    s_waitcnt vmcnt(16)
L_chk_7:
    v_max3_u32 v20, v40, v41, v42
    v_max3_u32 v20, v20, v43, v44
    v_max3_u32 v20, v20, v45, v46
    v_max3_u32 v20, v20, v47, v52
    v_max_u32 v20, v20, v53
    v_cmp_eq_u32 vcc, -1, v20
    s_cbranch_vccnz L_retry_8
L_done_9:
    v_permlane32_swap_b32 v44, v46
    v_permlane32_swap_b32 v45, v47
    v_pk_add_f32 v[44:45], v[44:45], v[46:47]
    s_nop 1
    v_permlane16_swap_b32 v44, v45
    v_add_f32 v44, v44, v45
    s_nop 1
    v_add_f32_dpp v44, v44, v44 row_ror:8 row_mask:0xf bank_mask:0xf
    v_cvt_pk_bf16_f32 v44, 0, v44
    v_or_b32 v1, v1, v44
    v_mov_b32 v54, 0x4575fdf0
    v_add_f32_dpp v53, v53, v53 row_ror:4 row_mask:0xf bank_mask:0xf
    v_permlane32_swap_b32 v40, v42
    v_add_f32_dpp v52, v52, v52 row_ror:4 row_mask:0xf bank_mask:0xf
    v_permlane32_swap_b32 v41, v43
    v_add_f32_dpp v53, v53, v53 row_ror:2 row_mask:0xf bank_mask:0xf
    v_pk_add_f32 v[40:41], v[40:41], v[42:43]
    v_add_f32_dpp v52, v52, v52 row_ror:2 row_mask:0xf bank_mask:0xf
    s_nop 0
    v_permlane16_swap_b32 v40, v41
    v_add_f32_dpp v53, v53, v53 row_ror:1 row_mask:0xf bank_mask:0xf
    v_add_f32 v40, v40, v41
    v_add_f32_dpp v52, v52, v52 row_ror:1 row_mask:0xf bank_mask:0xf
    s_nop 0
    v_add_f32_dpp v40, v40, v40 row_ror:8 row_mask:0xf bank_mask:0xf
    v_mul_f32 v53, 0x37e38e39, v53
    v_and_b32 v41, 0xffff0000, v1
    v_mul_f32 v52, 0x37e38e39, v52
    v_fma_f32 v52, -v53, v53, v52
    v_max_f32 v52, 0, v52
    v_fmaak_f32 v52, v54, v52, 0x3a21369a
    v_rsq_f32 v52, v52
    v_fma_f32 v40, -v53, v41, v40
    v_mul_f32 v40, v40, v52
    v_cvt_pk_bf16_f32 v40, v40, v40
    ds_write_b16 v48, v40
    s_waitcnt lgkmcnt(0)
    s_barrier
    ds_read_b128 v[56:59], v50
    ds_read_b128 v[60:63], v50 offset:128
    v_mov_b64 v[24:25], 0
    v_mov_b64 v[28:29], 0
    v_mov_b64 v[32:33], 0
    v_mov_b64 v[36:37], 0
    v_and_b32 v45, 0x32, v0
    v_lshlrev_b32 v45, 3, v45
    v_and_b32 v44, 8, v0
    v_lshl_or_b32 v45, v44, 2, v45
    v_and_b32 v44, 5, v0
    v_lshl_or_b32 v45, v44, 1, v45
    v_add_u32 v45, s68, v45
    s_waitcnt lgkmcnt(1)
    v_smfmac_f32_16x16x64_bf16 v[24:27], v[56:59], a[0:7], v1
    s_waitcnt lgkmcnt(0)
    v_smfmac_f32_16x16x64_bf16 v[24:27], v[60:63], a[8:15], v1
    v_smfmac_f32_16x16x64_bf16 v[28:31], v[56:59], a[16:23], v1
    v_smfmac_f32_16x16x64_bf16 v[28:31], v[60:63], a[24:31], v1
    v_smfmac_f32_16x16x64_bf16 v[32:35], v[56:59], a[32:39], v1
    v_smfmac_f32_16x16x64_bf16 v[32:35], v[60:63], a[40:47], v1
    s_nop 3
    v_add_f32_dpp v40, v24, v25 quad_perm:[0,1,2,3] row_mask:1 bank_mask:0xf
    v_mov_b64 v[24:25], 0
    v_smfmac_f32_16x16x64_bf16 v[36:39], v[56:59], a[48:55], v1
    v_smfmac_f32_16x16x64_bf16 v[36:39], v[60:63], a[56:63], v1
    v_add_f32_dpp v41, v28, v29 quad_perm:[0,1,2,3] row_mask:1 bank_mask:0xf
    v_mov_b64 v[28:29], 0
    v_smfmac_f32_16x16x64_bf16 v[24:27], v[56:59], a[64:71], v1
    v_smfmac_f32_16x16x64_bf16 v[24:27], v[60:63], a[72:79], v1
    v_add_f32_dpp v42, v32, v33 quad_perm:[0,1,2,3] row_mask:1 bank_mask:0xf
    v_mov_b64 v[32:33], 0
    v_smfmac_f32_16x16x64_bf16 v[28:31], v[56:59], a[80:87], v1
    v_smfmac_f32_16x16x64_bf16 v[28:31], v[60:63], a[88:95], v1
    v_add_f32_dpp v43, v36, v37 quad_perm:[0,1,2,3] row_mask:1 bank_mask:0xf
    v_mov_b64 v[36:37], 0
    v_smfmac_f32_16x16x64_bf16 v[32:35], v[56:59], a[96:103], v1
    v_smfmac_f32_16x16x64_bf16 v[32:35], v[60:63], a[104:111], v1
    v_add_f32_dpp v40, v24, v25 quad_perm:[0,1,2,3] row_mask:2 bank_mask:0xf
    v_mov_b64 v[24:25], 0
    v_smfmac_f32_16x16x64_bf16 v[36:39], v[56:59], a[112:119], v1
    v_smfmac_f32_16x16x64_bf16 v[36:39], v[60:63], a[120:127], v1
    v_add_f32_dpp v41, v28, v29 quad_perm:[0,1,2,3] row_mask:2 bank_mask:0xf
    v_mov_b64 v[28:29], 0
    v_smfmac_f32_16x16x64_bf16 v[24:27], v[56:59], a[128:135], v1
    v_smfmac_f32_16x16x64_bf16 v[24:27], v[60:63], a[136:143], v1
    v_add_f32_dpp v42, v32, v33 quad_perm:[0,1,2,3] row_mask:2 bank_mask:0xf
    v_mov_b64 v[32:33], 0
    v_smfmac_f32_16x16x64_bf16 v[28:31], v[56:59], a[144:151], v1
    v_smfmac_f32_16x16x64_bf16 v[28:31], v[60:63], a[152:159], v1
    v_add_f32_dpp v43, v36, v37 quad_perm:[0,1,2,3] row_mask:2 bank_mask:0xf
    v_mov_b64 v[36:37], 0
    v_smfmac_f32_16x16x64_bf16 v[32:35], v[56:59], a[160:167], v1
    v_smfmac_f32_16x16x64_bf16 v[32:35], v[60:63], a[168:175], v1
    v_add_f32_dpp v40, v24, v25 quad_perm:[0,1,2,3] row_mask:4 bank_mask:0xf
    v_mov_b64 v[24:25], 0
    v_smfmac_f32_16x16x64_bf16 v[36:39], v[56:59], a[176:183], v1
    v_smfmac_f32_16x16x64_bf16 v[36:39], v[60:63], a[184:191], v1
    v_add_f32_dpp v41, v28, v29 quad_perm:[0,1,2,3] row_mask:4 bank_mask:0xf
    v_mov_b64 v[28:29], 0
    v_smfmac_f32_16x16x64_bf16 v[24:27], v[56:59], a[192:199], v1
    v_smfmac_f32_16x16x64_bf16 v[24:27], v[60:63], a[200:207], v1
    v_add_f32_dpp v42, v32, v33 quad_perm:[0,1,2,3] row_mask:4 bank_mask:0xf
    v_mov_b64 v[32:33], 0
    v_smfmac_f32_16x16x64_bf16 v[28:31], v[56:59], a[208:215], v1
    v_smfmac_f32_16x16x64_bf16 v[28:31], v[60:63], a[216:223], v1
    v_add_f32_dpp v43, v36, v37 quad_perm:[0,1,2,3] row_mask:4 bank_mask:0xf
    v_mov_b64 v[36:37], 0
    v_smfmac_f32_16x16x64_bf16 v[32:35], v[56:59], a[224:231], v1
    v_smfmac_f32_16x16x64_bf16 v[32:35], v[60:63], a[232:239], v1
    v_add_f32_dpp v40, v24, v25 quad_perm:[0,1,2,3] row_mask:8 bank_mask:0xf
    v_smfmac_f32_16x16x64_bf16 v[36:39], v[56:59], a[240:247], v1
    v_smfmac_f32_16x16x64_bf16 v[36:39], v[60:63], a[248:255], v1
    s_nop 0
    v_add_f32_dpp v41, v28, v29 quad_perm:[0,1,2,3] row_mask:8 bank_mask:0xf
    s_nop 2
    v_add_f32_dpp v42, v32, v33 quad_perm:[0,1,2,3] row_mask:8 bank_mask:0xf
    s_nop 1
    v_add_f32_dpp v43, v36, v37 quad_perm:[0,1,2,3] row_mask:8 bank_mask:0xf
    v_max3_f32 v44, v40, v41, v42
    v_max_f32 v44, v44, v43
    s_nop 1
    v_max_f32_dpp v44, v44, v44 row_ror:8 row_mask:0xf bank_mask:0xf
    s_nop 1
    v_max_f32_dpp v44, v44, v44 row_ror:4 row_mask:0xf bank_mask:0xf
    s_nop 1
    v_max_f32_dpp v44, v44, v44 row_ror:2 row_mask:0xf bank_mask:0xf
    s_nop 1
    v_max_f32_dpp v44, v44, v44 row_ror:1 row_mask:0xf bank_mask:0xf
    s_nop 1
    v_max_f32_dpp v44, v44, v44 row_bcast:15 row_mask:0xa bank_mask:0xf
    s_nop 1
    v_max_f32_dpp v44, v44, v44 row_bcast:31 row_mask:0xc bank_mask:0xf
    s_nop 0
    v_readlane_b32 s73, v44, 63
    s_nop 1
    v_subrev_f32 v40, s73, v40
    v_subrev_f32 v41, s73, v41
    v_subrev_f32 v42, s73, v42
    v_subrev_f32 v43, s73, v43
    v_exp_f32 v40, v40
    v_exp_f32 v41, v41
    v_exp_f32 v42, v42
    v_exp_f32 v43, v43
    v_cvt_pk_bf16_f32 v46, v40, v41
    v_cvt_pk_bf16_f32 v47, v42, v43
    ds_write_b16 v45, v46 offset:6144
    ds_write_b16_d16_hi v45, v46 offset:6148
    ds_write_b16 v45, v47 offset:6208
    ds_write_b16_d16_hi v45, v47 offset:6212
    v_pk_add_f32 v[40:41], v[40:41], v[42:43]
    v_add_f32 v57, v40, v41
    s_nop 1
    v_add_f32_dpp v57, v57, v57 row_ror:8 row_mask:0xf bank_mask:0xf
    s_nop 1
    v_add_f32_dpp v57, v57, v57 row_ror:4 row_mask:0xf bank_mask:0xf
    s_nop 1
    v_add_f32_dpp v57, v57, v57 row_ror:2 row_mask:0xf bank_mask:0xf
    s_nop 1
    v_add_f32_dpp v57, v57, v57 row_ror:1 row_mask:0xf bank_mask:0xf
    s_nop 1
    v_add_f32_dpp v57, v57, v57 row_bcast:15 row_mask:0xa bank_mask:0xf
    s_nop 1
    v_add_f32_dpp v57, v57, v57 row_bcast:31 row_mask:0xc bank_mask:0xf
    s_lshl_b32 s78, s66, 3
    s_add_u32 s78, s78, 138240
    v_mov_b32 v58, 0x30000
    v_mov_b32 v56, s73
    v_writelane_b32 v58, s78, 63
    ds_write_b64 v58, v[56:57]
    v_mov_b64 v[24:25], 0
    v_mov_b64 v[28:29], 0
    v_mov_b64 v[32:33], 0
    v_mov_b64 v[36:37], 0
    v_mov_b64 v[40:41], 0
    v_mov_b64 v[44:45], 0
    v_mov_b64 v[48:49], 0
    v_mov_b64 v[52:53], 0
    s_waitcnt lgkmcnt(0)
    s_waitcnt vmcnt(5)
    s_add_u32 m0, s69, 0
    s_add_u32 s78, s70, 131072
    buffer_load_dwordx4 v10, s[8:11], s78 offen offset:2048 nt lds
    s_waitcnt vmcnt(5)
    s_add_u32 m0, s69, 0
    s_add_u32 s78, s70, 131072
    buffer_load_dwordx4 v11, s[8:11], s78 offen offset:3072 nt lds
    s_waitcnt vmcnt(5)
    s_add_u32 m0, s69, 4096
    s_add_u32 s78, s70, 147456
    buffer_load_dwordx4 v8, s[8:11], s78 offen offset:0 nt lds
    s_waitcnt vmcnt(5)
    s_add_u32 m0, s69, 4096
    s_add_u32 s78, s70, 147456
    buffer_load_dwordx4 v9, s[8:11], s78 offen offset:1024 nt lds
    ds_read_b64_tr_b16 v[134:135], v12 offset:12288
    ds_read_b64_tr_b16 v[142:143], v13 offset:12288
    ds_read_b64_tr_b16 v[150:151], v14 offset:12288
    ds_read_b64_tr_b16 v[158:159], v15 offset:12288
    ds_read_b64_tr_b16 v[166:167], v16 offset:12288
    ds_read_b64_tr_b16 v[174:175], v17 offset:12288
    ds_read_b64_tr_b16 v[182:183], v18 offset:12288
    ds_read_b64_tr_b16 v[190:191], v19 offset:12288
    s_waitcnt lgkmcnt(0)
    v_and_b32 v63, 48, v0
    v_lshlrev_b32 v63, 1, v63
    v_and_or_b32 v63, v6, 16, v63
    v_add_u32 v63, s68, v63
    ds_read_b128 v[20:23], v63 offset:6144
    s_waitcnt lgkmcnt(0)
    v_smfmac_f32_16x16x64_bf16 v[24:27], v[20:23], v[64:71], v1
    v_smfmac_f32_16x16x64_bf16 v[28:31], v[20:23], v[72:79], v1
    v_smfmac_f32_16x16x64_bf16 v[32:35], v[20:23], v[80:87], v1
    v_smfmac_f32_16x16x64_bf16 v[36:39], v[20:23], v[88:95], v1
    v_smfmac_f32_16x16x64_bf16 v[40:43], v[20:23], v[96:103], v1
    v_smfmac_f32_16x16x64_bf16 v[44:47], v[20:23], v[104:111], v1
    v_smfmac_f32_16x16x64_bf16 v[48:51], v[20:23], v[112:119], v1
    v_smfmac_f32_16x16x64_bf16 v[52:55], v[20:23], v[120:127], v1
    s_waitcnt vmcnt(5)
    s_add_u32 m0, s69, 4096
    s_add_u32 s78, s70, 147456
    buffer_load_dwordx4 v10, s[8:11], s78 offen offset:2048 nt lds
    s_waitcnt vmcnt(5)
    s_add_u32 m0, s69, 4096
    s_add_u32 s78, s70, 147456
    buffer_load_dwordx4 v11, s[8:11], s78 offen offset:3072 nt lds
    s_waitcnt vmcnt(5)
    s_add_u32 m0, s69, 8192
    s_add_u32 s78, s70, 163840
    buffer_load_dwordx4 v8, s[8:11], s78 offen offset:0 nt lds
    s_waitcnt vmcnt(5)
    s_add_u32 m0, s69, 8192
    s_add_u32 s78, s70, 163840
    buffer_load_dwordx4 v9, s[8:11], s78 offen offset:1024 nt lds
    ds_read_b64_tr_b16 v[192:193], v12 offset:0
    ds_read_b64_tr_b16 v[200:201], v13 offset:0
    ds_read_b64_tr_b16 v[208:209], v14 offset:0
    ds_read_b64_tr_b16 v[216:217], v15 offset:0
    ds_read_b64_tr_b16 v[224:225], v16 offset:0
    ds_read_b64_tr_b16 v[232:233], v17 offset:0
    ds_read_b64_tr_b16 v[240:241], v18 offset:0
    ds_read_b64_tr_b16 v[248:249], v19 offset:0
    s_waitcnt lgkmcnt(0)
    v_and_b32 v63, 48, v0
    v_lshlrev_b32 v63, 1, v63
    v_and_or_b32 v63, v6, 16, v63
    v_add_u32 v63, s68, v63
    ds_read_b128 v[20:23], v63 offset:6272
    s_waitcnt lgkmcnt(0)
    v_smfmac_f32_16x16x64_bf16 v[24:27], v[20:23], v[128:135], v1
    v_smfmac_f32_16x16x64_bf16 v[28:31], v[20:23], v[136:143], v1
    v_smfmac_f32_16x16x64_bf16 v[32:35], v[20:23], v[144:151], v1
    v_smfmac_f32_16x16x64_bf16 v[36:39], v[20:23], v[152:159], v1
    v_smfmac_f32_16x16x64_bf16 v[40:43], v[20:23], v[160:167], v1
    v_smfmac_f32_16x16x64_bf16 v[44:47], v[20:23], v[168:175], v1
    v_smfmac_f32_16x16x64_bf16 v[48:51], v[20:23], v[176:183], v1
    v_smfmac_f32_16x16x64_bf16 v[52:55], v[20:23], v[184:191], v1
    s_waitcnt vmcnt(5)
    s_add_u32 m0, s69, 8192
    s_add_u32 s78, s70, 163840
    buffer_load_dwordx4 v10, s[8:11], s78 offen offset:2048 nt lds
    buffer_load_dwordx4 v11, s[8:11], s78 offen offset:3072 nt lds
    s_add_u32 m0, s69, 12288
    s_add_u32 s78, s70, 180224
    buffer_load_dwordx4 v8, s[8:11], s78 offen offset:0 nt lds
    buffer_load_dwordx4 v9, s[8:11], s78 offen offset:1024 nt lds
    s_waitcnt vmcnt(8)
    s_add_u32 m0, s69, 12288
    s_add_u32 s78, s70, 180224
    buffer_load_dwordx4 v10, s[8:11], s78 offen offset:2048 nt lds
    s_waitcnt vmcnt(8)
    s_add_u32 m0, s69, 12288
    s_add_u32 s78, s70, 180224
    buffer_load_dwordx4 v11, s[8:11], s78 offen offset:3072 nt lds
    s_waitcnt vmcnt(8)
    s_add_u32 m0, s69, 0
    s_add_u32 s78, s70, 196608
    buffer_load_dwordx4 v8, s[8:11], s78 offen offset:0 nt lds
    ds_read_b64_tr_b16 v[194:195], v12 offset:4096
    ds_read_b64_tr_b16 v[202:203], v13 offset:4096
    ds_read_b64_tr_b16 v[210:211], v14 offset:4096
    ds_read_b64_tr_b16 v[218:219], v15 offset:4096
    ds_read_b64_tr_b16 v[226:227], v16 offset:4096
    ds_read_b64_tr_b16 v[234:235], v17 offset:4096
    ds_read_b64_tr_b16 v[242:243], v18 offset:4096
    ds_read_b64_tr_b16 v[250:251], v19 offset:4096
    s_waitcnt lgkmcnt(0)
    s_waitcnt vmcnt(8)
    s_add_u32 m0, s69, 0
    s_add_u32 s78, s70, 196608
    buffer_load_dwordx4 v9, s[8:11], s78 offen offset:1024 nt lds
    s_waitcnt vmcnt(8)
    s_add_u32 m0, s69, 0
    s_add_u32 s78, s70, 196608
    buffer_load_dwordx4 v10, s[8:11], s78 offen offset:2048 nt lds
    s_waitcnt vmcnt(8)
    s_add_u32 m0, s69, 0
    s_add_u32 s78, s70, 196608
    buffer_load_dwordx4 v11, s[8:11], s78 offen offset:3072 nt lds
    s_waitcnt vmcnt(8)
    s_add_u32 m0, s69, 4096
    s_add_u32 s78, s70, 212992
    buffer_load_dwordx4 v8, s[8:11], s78 offen offset:0 nt lds
    ds_read_b64_tr_b16 v[196:197], v12 offset:8192
    ds_read_b64_tr_b16 v[204:205], v13 offset:8192
    ds_read_b64_tr_b16 v[212:213], v14 offset:8192
    ds_read_b64_tr_b16 v[220:221], v15 offset:8192
    ds_read_b64_tr_b16 v[228:229], v16 offset:8192
    ds_read_b64_tr_b16 v[236:237], v17 offset:8192
    ds_read_b64_tr_b16 v[244:245], v18 offset:8192
    ds_read_b64_tr_b16 v[252:253], v19 offset:8192
    s_waitcnt lgkmcnt(0)
    s_barrier
    v_mov_b32 v20, 138240
    ds_read_b128 v[56:59], v20
    ds_read_b128 v[60:63], v20 offset:16
    s_waitcnt lgkmcnt(0)
    v_max3_f32 v20, v56, v58, v60
    v_max_f32 v20, v20, v62
    v_sub_f32 v56, v56, v20
    v_sub_f32 v58, v58, v20
    v_sub_f32 v60, v60, v20
    v_sub_f32 v62, v62, v20
    v_sub_f32 v21, s73, v20
    v_exp_f32 v56, v56
    v_exp_f32 v58, v58
    v_exp_f32 v60, v60
    v_exp_f32 v62, v62
    v_exp_f32 v21, v21
    v_mul_f32 v22, v56, v57
    v_fmac_f32 v22, v58, v59
    v_fmac_f32 v22, v60, v61
    v_fmac_f32 v22, v62, v63
    v_rcp_f32 v56, v22
    v_log_f32 v22, v22
    v_mul_f32 v21, v21, v56
    v_add_f32 v22, v22, v20
    v_readfirstlane_b32 s22, v21
    v_readfirstlane_b32 s23, v22
    s_waitcnt vmcnt(8)
    s_add_u32 m0, s69, 4096
    s_add_u32 s78, s70, 212992
    buffer_load_dwordx4 v9, s[8:11], s78 offen offset:1024 nt lds
    s_waitcnt vmcnt(8)
    s_add_u32 m0, s69, 4096
    s_add_u32 s78, s70, 212992
    buffer_load_dwordx4 v10, s[8:11], s78 offen offset:2048 nt lds
    s_waitcnt vmcnt(8)
    s_add_u32 m0, s69, 4096
    s_add_u32 s78, s70, 212992
    buffer_load_dwordx4 v11, s[8:11], s78 offen offset:3072 nt lds
    s_waitcnt vmcnt(8)
    s_add_u32 m0, s69, 8192
    s_add_u32 s78, s70, 229376
    buffer_load_dwordx4 v8, s[8:11], s78 offen offset:0 nt lds
    ds_read_b64_tr_b16 v[198:199], v12 offset:12288
    ds_read_b64_tr_b16 v[206:207], v13 offset:12288
    ds_read_b64_tr_b16 v[214:215], v14 offset:12288
    ds_read_b64_tr_b16 v[222:223], v15 offset:12288
    ds_read_b64_tr_b16 v[230:231], v16 offset:12288
    ds_read_b64_tr_b16 v[238:239], v17 offset:12288
    ds_read_b64_tr_b16 v[246:247], v18 offset:12288
    ds_read_b64_tr_b16 v[254:255], v19 offset:12288
    s_waitcnt lgkmcnt(0)
    s_add_u32 m0, s69, 8192
    s_add_u32 s78, s70, 229376
    buffer_load_dwordx4 v9, s[8:11], s78 offen offset:1024 nt lds
    buffer_load_dwordx4 v10, s[8:11], s78 offen offset:2048 nt lds
    buffer_load_dwordx4 v11, s[8:11], s78 offen offset:3072 nt lds
    s_add_u32 m0, s69, 12288
    s_add_u32 s78, s70, 245760
    buffer_load_dwordx4 v8, s[8:11], s78 offen offset:0 nt lds
    buffer_load_dwordx4 v9, s[8:11], s78 offen offset:1024 nt lds
    buffer_load_dwordx4 v10, s[8:11], s78 offen offset:2048 nt lds
    buffer_load_dwordx4 v11, s[8:11], s78 offen offset:3072 nt lds
L_join:
    s_add_u32 s0, s12, s1
    s_addc_u32 s1, s13, 0
    s_lshr_b32 s79, s65, 3
    s_and_b32 s80, s65, 1
    s_lshr_b32 s81, s65, 1
    s_lshr_b32 s82, s64, 2
    s_and_b32 s83, s64, 3
    s_lshl_b32 s4, s66, 12
    s_add_u32 s4, s4, 16384
    s_lshl_b32 s5, s66, 6
    s_add_u32 s5, s5, 53504
    s_lshl_b32 s6, s82, 14
    s_lshl_b32 s78, s81, 10
    s_add_u32 s6, s6, s78
    s_lshl_b32 s78, s83, 8
    s_add_u32 s6, s6, s78
    s_lshl_b32 s78, s80, 7
    s_add_u32 s6, s6, s78
    s_add_u32 s6, s6, 49152
    s_lshl_b32 s7, s80, 14
    s_lshl_b32 s78, s66, 12
    s_add_u32 s7, s7, s78
    s_add_u32 s7, s7, 49152
    s_lshl_b32 s8, s64, 19
    s_lshl_b32 s78, s80, 18
    s_add_u32 s8, s8, s78
    s_lshl_b32 s78, s66, 14
    s_add_u32 s8, s8, s78
    s_lshl_b32 s78, s81, 8
    s_add_u32 s8, s8, s78
    s_add_u32 s8, s8, 2097152
    s_and_b32 s82, s81, 3
    s_lshl_b32 s9, s80, 11
    s_lshl_b32 s78, s82, 7
    s_add_u32 s9, s9, s78
    s_lshl_b32 s78, s79, 3
    s_add_u32 s9, s9, s78
    s_add_u32 s9, s9, 49152
    s_lshl_b32 s10, s64, 19
    s_lshl_b32 s78, s65, 14
    s_add_u32 s10, s10, s78
    s_lshl_b32 s78, s66, 12
    s_add_u32 s10, s10, s78
    s_add_u32 s10, s10, 2097152
    s_lshr_b32 s82, s65, 2
    s_lshl_b32 s11, s82, 9
    s_add_u32 s11, s11, 49152
    s_lshl_b32 s12, s65, 13
    s_lshl_b32 s78, s66, 11
    s_add_u32 s12, s12, s78
    s_lshl_b32 s78, s64, 8
    s_add_u32 s12, s12, s78
    s_add_u32 s12, s12, 114688
    s_lshl_b32 s13, s82, 10
    s_lshl_b32 s78, s64, 7
    s_add_u32 s13, s13, s78
    s_add_u32 s13, s13, 81920
    s_and_b32 s82, s65, 3
    s_cselect_b32 s13, 1073741824, s13
    s_lshl_b32 s14, s64, 15
    s_lshl_b32 s78, s77, 12
    s_add_u32 s14, s14, s78
    s_lshl_b32 s78, s79, 6
    s_add_u32 s14, s14, s78
    s_add_u32 s14, s14, 114688
    s_lshl_b32 s15, s64, 10
    s_lshl_b32 s78, s79, 4
    s_add_u32 s15, s15, s78
    s_add_u32 s15, s15, 81920
    s_lshl_b32 s16, s79, 11
    s_lshl_b32 s78, s66, 9
    s_add_u32 s16, s16, s78
    s_lshl_b32 s78, s77, 5
    s_add_u32 s16, s16, s78
    s_add_u32 s16, s16, 40960
    s_lshl_b32 s17, s79, 11
    s_lshl_b32 s78, s77, 5
    s_add_u32 s17, s17, s78
    s_add_u32 s17, s17, 32768
    s_lshl_b32 s18, s65, 2
    s_add_u32 s18, s18, 53760
    s_lshl_b32 s19, s66, 5
    s_add_u32 s19, s19, 53760
    s_lshl_b32 s20, s65, 7
    s_lshl_b32 s21, s66, 11
    s_add_u32 s21, s21, 32768
    s_cmp_eq_u32 s66, 0
    s_cselect_b32 s9, s9, 1073741824
    s_cselect_b32 s17, s17, 1073741824
    s_cselect_b32 s13, s13, 1073741824
    v_mov_b32 v62, s23
    s_cmp_eq_u32 s66, 0
    s_cselect_b32 s79, s18, 1073741824
    s_cmp_eq_u32 s67, 0
    s_cbranch_scc1 L_slow_10
    buffer_store_dword v62, off, s[52:55], s79
L_back_11:
    v_and_b32 v63, 48, v0
    v_lshlrev_b32 v63, 1, v63
    v_and_or_b32 v63, v6, 16, v63
    v_add_u32 v63, s68, v63
    ds_read_b128 v[20:23], v63 offset:6400
    s_waitcnt lgkmcnt(0)
    v_smfmac_f32_16x16x64_bf16 v[24:27], v[20:23], v[192:199], v1
    v_smfmac_f32_16x16x64_bf16 v[28:31], v[20:23], v[200:207], v1
    v_smfmac_f32_16x16x64_bf16 v[32:35], v[20:23], v[208:215], v1
    v_smfmac_f32_16x16x64_bf16 v[36:39], v[20:23], v[216:223], v1
    v_smfmac_f32_16x16x64_bf16 v[40:43], v[20:23], v[224:231], v1
    v_smfmac_f32_16x16x64_bf16 v[44:47], v[20:23], v[232:239], v1
    v_smfmac_f32_16x16x64_bf16 v[48:51], v[20:23], v[240:247], v1
    v_smfmac_f32_16x16x64_bf16 v[52:55], v[20:23], v[248:255], v1
    v_lshrrev_b32 v62, 1, v0
    v_and_b32 v62, 8, v62
    v_and_or_b32 v62, v0, 32, v62
    v_add_u32 v62, s68, v62
    v_add_u32 v62, 6528, v62
    ds_read2_b32 v[20:21], v62 offset0:0 offset1:4
    ds_read2_b32 v[22:23], v62 offset0:1 offset1:5
    ds_read2_b32 v[8:9], v62 offset0:16 offset1:20
    ds_read2_b32 v[10:11], v62 offset0:17 offset1:21
    s_mov_b32 vcc_lo, 0x55555555
    s_mov_b32 vcc_hi, 0x55555555
    s_waitcnt lgkmcnt(0)
    v_cndmask_b32 v20, 0, v20, vcc
    v_cndmask_b32 v21, 0, v21, vcc
    v_cndmask_b32 v22, 0, v22, vcc
    v_cndmask_b32 v23, 0, v23, vcc
    v_cndmask_b32 v8, 0, v8, vcc
    v_cndmask_b32 v9, 0, v9, vcc
    v_cndmask_b32 v10, 0, v10, vcc
    v_cndmask_b32 v11, 0, v11, vcc
    s_waitcnt vmcnt(13)
    ds_read_b64_tr_b16 v[56:57], v12 offset:0
    ds_read_b64_tr_b16 v[58:59], v13 offset:0
    ds_read_b64_tr_b16 v[60:61], v14 offset:0
    ds_read_b64_tr_b16 v[62:63], v15 offset:0
    s_waitcnt lgkmcnt(3)
    v_mfma_f32_16x16x16_bf16 v[24:27], v[20:21], v[56:57], v[24:27]
    ds_read_b64_tr_b16 v[56:57], v16 offset:0
    s_waitcnt lgkmcnt(3)
    v_mfma_f32_16x16x16_bf16 v[28:31], v[20:21], v[58:59], v[28:31]
    ds_read_b64_tr_b16 v[58:59], v17 offset:0
    s_waitcnt lgkmcnt(3)
    v_mfma_f32_16x16x16_bf16 v[32:35], v[20:21], v[60:61], v[32:35]
    ds_read_b64_tr_b16 v[60:61], v18 offset:0
    s_waitcnt lgkmcnt(3)
    v_mfma_f32_16x16x16_bf16 v[36:39], v[20:21], v[62:63], v[36:39]
    ds_read_b64_tr_b16 v[62:63], v19 offset:0
    s_waitcnt lgkmcnt(3)
    v_mfma_f32_16x16x16_bf16 v[40:43], v[20:21], v[56:57], v[40:43]
    s_waitcnt lgkmcnt(2)
    v_mfma_f32_16x16x16_bf16 v[44:47], v[20:21], v[58:59], v[44:47]
    s_waitcnt lgkmcnt(1)
    v_mfma_f32_16x16x16_bf16 v[48:51], v[20:21], v[60:61], v[48:51]
    s_waitcnt lgkmcnt(0)
    v_mfma_f32_16x16x16_bf16 v[52:55], v[20:21], v[62:63], v[52:55]
    s_waitcnt vmcnt(9)
    ds_read_b64_tr_b16 v[56:57], v12 offset:4096
    ds_read_b64_tr_b16 v[58:59], v13 offset:4096
    ds_read_b64_tr_b16 v[60:61], v14 offset:4096
    ds_read_b64_tr_b16 v[62:63], v15 offset:4096
    s_waitcnt lgkmcnt(3)
    v_mfma_f32_16x16x16_bf16 v[24:27], v[22:23], v[56:57], v[24:27]
    ds_read_b64_tr_b16 v[56:57], v16 offset:4096
    s_waitcnt lgkmcnt(3)
    v_mfma_f32_16x16x16_bf16 v[28:31], v[22:23], v[58:59], v[28:31]
    ds_read_b64_tr_b16 v[58:59], v17 offset:4096
    s_waitcnt lgkmcnt(3)
    v_mfma_f32_16x16x16_bf16 v[32:35], v[22:23], v[60:61], v[32:35]
    ds_read_b64_tr_b16 v[60:61], v18 offset:4096
    s_waitcnt lgkmcnt(3)
    v_mfma_f32_16x16x16_bf16 v[36:39], v[22:23], v[62:63], v[36:39]
    ds_read_b64_tr_b16 v[62:63], v19 offset:4096
    s_waitcnt lgkmcnt(3)
    v_mfma_f32_16x16x16_bf16 v[40:43], v[22:23], v[56:57], v[40:43]
    s_waitcnt lgkmcnt(2)
    v_mfma_f32_16x16x16_bf16 v[44:47], v[22:23], v[58:59], v[44:47]
    s_waitcnt lgkmcnt(1)
    v_mfma_f32_16x16x16_bf16 v[48:51], v[22:23], v[60:61], v[48:51]
    s_waitcnt lgkmcnt(0)
    v_mfma_f32_16x16x16_bf16 v[52:55], v[22:23], v[62:63], v[52:55]
    s_waitcnt vmcnt(5)
    ds_read_b64_tr_b16 v[56:57], v12 offset:8192
    ds_read_b64_tr_b16 v[58:59], v13 offset:8192
    ds_read_b64_tr_b16 v[60:61], v14 offset:8192
    ds_read_b64_tr_b16 v[62:63], v15 offset:8192
    s_waitcnt lgkmcnt(3)
    v_mfma_f32_16x16x16_bf16 v[24:27], v[8:9], v[56:57], v[24:27]
    ds_read_b64_tr_b16 v[56:57], v16 offset:8192
    s_waitcnt lgkmcnt(3)
    v_mfma_f32_16x16x16_bf16 v[28:31], v[8:9], v[58:59], v[28:31]
    ds_read_b64_tr_b16 v[58:59], v17 offset:8192
    s_waitcnt lgkmcnt(3)
    v_mfma_f32_16x16x16_bf16 v[32:35], v[8:9], v[60:61], v[32:35]
    ds_read_b64_tr_b16 v[60:61], v18 offset:8192
    s_waitcnt lgkmcnt(3)
    v_mfma_f32_16x16x16_bf16 v[36:39], v[8:9], v[62:63], v[36:39]
    ds_read_b64_tr_b16 v[62:63], v19 offset:8192
    s_waitcnt lgkmcnt(3)
    v_mfma_f32_16x16x16_bf16 v[40:43], v[8:9], v[56:57], v[40:43]
    s_waitcnt lgkmcnt(2)
    v_mfma_f32_16x16x16_bf16 v[44:47], v[8:9], v[58:59], v[44:47]
    s_waitcnt lgkmcnt(1)
    v_mfma_f32_16x16x16_bf16 v[48:51], v[8:9], v[60:61], v[48:51]
    s_waitcnt lgkmcnt(0)
    v_mfma_f32_16x16x16_bf16 v[52:55], v[8:9], v[62:63], v[52:55]
    s_cmp_eq_u32 s67, 0
    s_cbranch_scc1 L_pre_slow
    s_waitcnt vmcnt(1)
    ds_read_b64_tr_b16 v[56:57], v12 offset:12288
    ds_read_b64_tr_b16 v[58:59], v13 offset:12288
    ds_read_b64_tr_b16 v[60:61], v14 offset:12288
    ds_read_b64_tr_b16 v[62:63], v15 offset:12288
    ds_read_b64_tr_b16 v[20:21], v16 offset:12288
    ds_read_b64_tr_b16 v[22:23], v17 offset:12288
    ds_read_b64_tr_b16 v[8:9], v18 offset:12288
    ds_read_b64_tr_b16 v[12:13], v19 offset:12288
    v_lshrrev_b32 v14, 4, v0
    v_lshl_add_u32 v14, v14, 1, v0
    v_and_b32 v14, 7, v14
    v_lshlrev_b32 v14, 2, v14
    s_waitcnt lgkmcnt(7)
    v_mfma_f32_16x16x16_bf16 v[24:27], v[10:11], v[56:57], v[24:27]
    s_waitcnt lgkmcnt(6)
    v_mfma_f32_16x16x16_bf16 v[28:31], v[10:11], v[58:59], v[28:31]
    s_waitcnt lgkmcnt(5)
    v_mfma_f32_16x16x16_bf16 v[32:35], v[10:11], v[60:61], v[32:35]
    s_waitcnt lgkmcnt(4)
    v_mfma_f32_16x16x16_bf16 v[36:39], v[10:11], v[62:63], v[36:39]
    s_waitcnt lgkmcnt(3)
    v_mfma_f32_16x16x16_bf16 v[40:43], v[10:11], v[20:21], v[40:43]
    v_add_f32_dpp v16, v24, v25 quad_perm:[0,1,2,3] row_mask:1 bank_mask:0xf
    s_waitcnt lgkmcnt(2)
    v_mfma_f32_16x16x16_bf16 v[44:47], v[10:11], v[22:23], v[44:47]
    v_add_f32_dpp v16, v28, v29 quad_perm:[0,1,2,3] row_mask:2 bank_mask:0xf
    s_waitcnt lgkmcnt(1)
    v_mfma_f32_16x16x16_bf16 v[48:51], v[10:11], v[8:9], v[48:51]
    v_add_f32_dpp v16, v32, v33 quad_perm:[0,1,2,3] row_mask:4 bank_mask:0xf
    s_waitcnt lgkmcnt(0)
    v_mfma_f32_16x16x16_bf16 v[52:55], v[10:11], v[12:13], v[52:55]
    v_add_f32_dpp v16, v36, v37 quad_perm:[0,1,2,3] row_mask:8 bank_mask:0xf
    v_add_f32_dpp v17, v40, v41 quad_perm:[0,1,2,3] row_mask:1 bank_mask:0xf
    v_add_f32_dpp v17, v44, v45 quad_perm:[0,1,2,3] row_mask:2 bank_mask:0xf
    s_nop 1
    v_add_f32_dpp v17, v48, v49 quad_perm:[0,1,2,3] row_mask:4 bank_mask:0xf
    s_nop 1
    v_add_f32_dpp v17, v52, v53 quad_perm:[0,1,2,3] row_mask:8 bank_mask:0xf
    v_mul_f32 v44, s22, v16
    v_mul_f32 v45, s22, v17
    v_lshl_add_u32 v46, v0, 2, s68
    v_mov_b32 v47, v14
L_top_fast:
    ds_write2st64_b32 v46, v44, v45 offset0:26 offset1:27
    v_mov_b32 v10, 137728
    v_lshl_add_u32 v8, v0, 3, v10
    v_and_b32 v10, 56, v0
    v_lshlrev_b32 v10, 5, v10
    v_and_or_b32 v10, v6, 16, v10
    v_and_b32 v11, 6, v0
    v_lshl_or_b32 v10, v11, 1, v10
    s_cmp_lg_u32 s66, 0
    s_waitcnt lgkmcnt(0)
    s_barrier
    ds_read_b64 v[20:21], v8 offset:0
    ds_read_b64 v[22:23], v8 offset:8192
    ds_read_b64 v[24:25], v8 offset:16384
    ds_read_b64 v[26:27], v8 offset:24576
    buffer_load_dword v16, v47, s[52:55], s19 offen sc1
    s_cbranch_scc1 L_notw_12
    s_waitcnt lgkmcnt(2)
    v_pk_add_f32 v[20:21], v[20:21], v[22:23]
    s_waitcnt lgkmcnt(0)
    v_pk_add_f32 v[24:25], v[24:25], v[26:27]
    v_pk_add_f32 v[20:21], v[20:21], v[24:25]
    v_cvt_pk_bf16_f32 v20, v20, v21
L_notw_12:
    buffer_store_dword v20, v10, s[52:55], s17 offen
    s_waitcnt lgkmcnt(0)
    s_mul_i32 s78, s74, s71
    s_cmp_eq_u32 s78, 3
    s_cbranch_scc1 L_res_13
L_resback_14:
    s_mul_i32 s78, s71, 393216
    s_add_u32 s56, s56, s78
    s_addc_u32 s57, s57, 0
    s_cmp_ge_u32 s65, 24
    s_cbranch_scc1 L_go_18
    v_lshrrev_b32 v28, 4, v0
    v_bfe_u32 v29, v0, 2, 2
    v_lshl_add_u32 v28, v28, 3, v29
    v_mul_u32_u24 v28, 48, v28
    v_and_b32 v29, 3, v0
    v_lshl_add_u32 v28, v29, 3, v28
    v_add_u32 v28, s68, v28
    s_lshl_b32 s80, s66, 3
    s_add_u32 s80, s80, 146432
    s_waitcnt vmcnt(1)
    ds_read_b64_tr_b16 v[32:33], v28 offset:0
    ds_read_b64_tr_b16 v[34:35], v28 offset:192
    ds_read_b64_tr_b16 v[36:37], v28 offset:1536
    ds_read_b64_tr_b16 v[38:39], v28 offset:1728
    ds_read_b64_tr_b16 v[48:49], v28 offset:32
    ds_read_b64_tr_b16 v[50:51], v28 offset:224
    ds_read_b64_tr_b16 v[52:53], v28 offset:1568
    ds_read_b64_tr_b16 v[54:55], v28 offset:1760
L_chk_20:
    v_cmp_eq_u32 vcc, -1, v16
    v_mov_b32 v22, v16
    s_cbranch_vccnz L_retry_23
L_got_22:
    buffer_load_dwordx4 v[8:11], v6, s[52:55], s21 offen sc1
    buffer_load_dwordx4 v[12:15], v6, s[52:55], s21 offen offset:1024 sc1
    ds_read_b64_tr_b16 v[40:41], v28 offset:3072
    v_max_f32_dpp v17, v22, v22 row_ror:4 row_mask:0xf bank_mask:0xf
    ds_read_b64_tr_b16 v[42:43], v28 offset:3264
    v_and_b32 v18, 15, v0
    ds_read_b64_tr_b16 v[44:45], v28 offset:4608
    v_max_f32_dpp v17, v17, v17 row_ror:2 row_mask:0xf bank_mask:0xf
    ds_read_b64_tr_b16 v[46:47], v28 offset:4800
    v_lshrrev_b32 v19, 5, v0
    ds_read_b64_tr_b16 v[56:57], v28 offset:3104
    v_max_f32_dpp v17, v17, v17 row_ror:1 row_mask:0xf bank_mask:0xf
    ds_read_b64_tr_b16 v[58:59], v28 offset:3296
    v_lshl_add_u32 v18, v19, 4, v18
    ds_read_b64_tr_b16 v[60:61], v28 offset:4640
    v_sub_f32 v22, v22, v17
    ds_read_b64_tr_b16 v[62:63], v28 offset:4832
    v_bfe_u32 v19, v0, 4, 1
    v_exp_f32 v22, v22
    v_lshlrev_b32 v19, 2, v19
    s_nop 0
    v_add_f32_dpp v17, v22, v22 row_ror:4 row_mask:0xf bank_mask:0xf
    v_lshl_add_u32 v18, v18, 5, v19
    s_nop 0
    v_add_f32_dpp v17, v17, v17 row_ror:2 row_mask:0xf bank_mask:0xf
    v_add_u32 v18, s80, v18
    s_nop 0
    v_add_f32_dpp v17, v17, v17 row_ror:1 row_mask:0xf bank_mask:0xf
    v_mov_b32 v19, 146432
    v_rcp_f32 v17, v17
    v_and_b32 v29, 15, v0
    s_nop 0
    v_mul_f32_dpp v30, v22, v17 row_newbcast:0 row_mask:0xf bank_mask:0xf
    v_lshl_add_u32 v19, v29, 6, v19
    v_mul_f32_dpp v31, v22, v17 row_newbcast:1 row_mask:0xf bank_mask:0xf
    v_lshlrev_b32 v29, 2, v0
    s_add_u32 s80, s96, 0
    v_lshrrev_b32 v28, 4, v0
    v_lshlrev_b32 v17, 5, v28
    v_xor_b32 v17, v17, v6
    s_lshl_b32 s79, s66, 7
    v_xor_b32 v17, s79, v17
    v_and_b32 v17, 0xf0, v17
    v_lshl_or_b32 v17, v28, 13, v17
L_poll_24:
    buffer_load_dwordx4 v[8:11], v6, s[52:55], s21 offen sc1
    buffer_load_dwordx4 v[12:15], v6, s[52:55], s21 offen offset:1024 sc1
    v_mov_b64 v[26:27], 0
    v_mov_b64 v[24:25], 0
    v_mov_b64 v[22:23], 0
    v_mov_b64 v[20:21], 0
    s_waitcnt vmcnt(2) lgkmcnt(0)
    v_cmp_u_f32 vcc, v8, v12
    v_smfmac_f32_16x16x64_bf16 v[20:23], v[8:11], v[32:39], v1
    v_smfmac_f32_16x16x64_bf16 v[20:23], v[12:15], v[40:47], v1
    s_cbranch_vccnz L_retry_26
L_got_25:
    v_smfmac_f32_16x16x64_bf16 v[24:27], v[8:11], v[48:55], v1
    v_smfmac_f32_16x16x64_bf16 v[24:27], v[12:15], v[56:63], v1
    s_nop 4
    v_pk_mul_f32 v[20:21], v[20:21], v[30:31] op_sel_hi:[1,0]
    v_pk_fma_f32 v[20:21], v[22:23], v[30:31], v[20:21] op_sel:[0,1,0] op_sel_hi:[1,1,1]
    s_nop 0
    v_pk_mul_f32 v[24:25], v[24:25], v[30:31] op_sel_hi:[1,0]
    v_add_f32 v20, v20, v21
    v_pk_fma_f32 v[24:25], v[26:27], v[30:31], v[24:25] op_sel:[0,1,0] op_sel_hi:[1,1,1]
    v_add_f32 v24, v24, v25
    v_cmp_u_f32 vcc, v20, v20
    s_nop 0
    v_permlane32_swap_b32 v20, v24
    v_add_f32 v20, v20, v24
    ds_write_b32 v18, v20
    s_cbranch_vccnz L_retry_28
L_got_27:
    s_bitcmp0_b32 s74, 0
    s_waitcnt vmcnt(0) lgkmcnt(0)
    s_barrier
    s_cbranch_scc1 L_noy_29
    ds_read_b128 v[32:35], v19 offset:0
    ds_read_b128 v[36:39], v19 offset:16
    ds_read_b128 v[40:43], v19 offset:32
    ds_read_b128 v[44:47], v19 offset:48
    s_mov_b32 exec_hi, 0
    s_waitcnt lgkmcnt(2)
    v_pk_add_f32 v[32:33], v[32:33], v[34:35]
    v_pk_add_f32 v[36:37], v[36:37], v[38:39]
    v_pk_add_f32 v[32:33], v[32:33], v[36:37]
    v_add_f32 v32, v32, v33
    s_waitcnt lgkmcnt(0)
    v_pk_add_f32 v[40:41], v[40:41], v[42:43]
    v_pk_add_f32 v[44:45], v[44:45], v[46:47]
    v_pk_add_f32 v[40:41], v[40:41], v[44:45]
    v_add_f32 v33, v40, v41
    v_pk_add_f32 v[32:33], v[32:33], v[4:5]
    v_cvt_pk_bf16_f32 v34, v32, v33
    buffer_store_dword v34, v29, s[56:59], s80 offen sc1
    s_mov_b32 exec_hi, -1
L_noy_29:
    s_add_u32 m0, s68, 0
    s_add_u32 s79, s92, 0
    buffer_load_dwordx4 v17, s[32:35], s79 offen offset:0  lds
    s_add_u32 s79, s92, 31744
    buffer_load_dwordx4 v17, s[32:35], s79 offen offset:1024  lds
    s_add_u32 s79, s92, 63488
    buffer_load_dwordx4 v17, s[32:35], s79 offen offset:2048  lds
    s_add_u32 m0, s68, 3072
    s_add_u32 s79, s92, 98304
    buffer_load_dwordx4 v17, s[32:35], s79 offen offset:0  lds
    s_add_u32 s79, s92, 130048
    buffer_load_dwordx4 v17, s[32:35], s79 offen offset:1024  lds
    s_add_u32 s79, s92, 161792
    buffer_load_dwordx4 v17, s[32:35], s79 offen offset:2048  lds
    s_barrier
    s_cmp_eq_u32 s74, 3
    s_cselect_b64 vcc, -1, 0
    v_lshlrev_b32 v36, 16, v34
    v_and_b32 v37, 0xffff0000, v34
    v_pk_add_f32 v[32:33], v[32:33], v[36:37] neg_lo:[0,1] neg_hi:[0,1]
    v_cndmask_b32 v4, 0, v32, vcc
    v_cndmask_b32 v5, 0, v33, vcc
    v_mov_b32 v53, 0x3f803f80
    s_lshl_b64 s[82:83], s[84:85], 8
    v_cndmask_b32 v16, 0, v53, s[82:83]
    v_mov_b32 v17, v16
    v_mov_b64 v[18:19], v[16:17]
    v_mov_b64 v[20:21], v[16:17]
    v_mov_b64 v[22:23], v[16:17]
    v_mov_b64 v[24:25], v[16:17]
    v_mov_b64 v[26:27], v[16:17]
    v_lshrrev_b32 v12, 2, v0
    v_mul_u32_u24 v12, 3072, v12
    v_and_or_b32 v12, v6, 48, v12
    s_add_u32 s82, s86, 0
    s_add_u32 s83, s68, 6144
    v_lshrrev_b32 v52, 4, v0
    v_bfe_u32 v53, v0, 2, 2
    v_lshl_add_u32 v52, v52, 5, v53
    v_and_b32 v53, 31, v0
    v_lshlrev_b32 v53, 3, v53
    v_lshl_or_b32 v52, v52, 8, v53
    s_lshl_b32 s78, s66, 6
    s_add_u32 s78, s78, 131072
    v_xor_b32 v52, s78, v52
    v_xor_b32 v54, 32, v52
    v_lshlrev_b32 v14, 3, v0
    v_and_b32 v14, 16, v14
    v_and_or_b32 v14, v0, 12, v14
    v_and_b32 v15, 16, v0
    v_lshl_or_b32 v14, v15, 4, v14
    v_and_b32 v15, 32, v0
    v_lshl_or_b32 v14, v15, 6, v14
    v_lshrrev_b32 v15, 1, v0
    s_mov_b32 vcc_lo, 2863311530
    s_mov_b32 vcc_hi, 2863311530
    v_cndmask_b32 v14, v14, 2.0, vcc
    s_sub_u32 s78, s89, s88
    s_add_u32 s78, s78, 256
    v_writelane_b32 v14, s78, 1
    s_add_u32 s78, s78, 4
    v_writelane_b32 v14, s78, 9
    s_mov_b64 s[22:23], 0x202
    v_and_b32 v11, 48, v0
    v_lshlrev_b32 v11, 3, v11
    v_and_or_b32 v11, v0, 7, v11
    v_lshlrev_b32 v11, 6, v11
    v_add_u32 v11, 137216, v11
    v_mov_b32 v13, 0
    v_lshrrev_b32 v9, 4, v0
    v_lshlrev_b32 v8, 5, v9
    v_xor_b32 v8, v8, v6
    v_and_b32 v8, 0xf0, v8
    v_lshl_or_b32 v8, v9, 13, v8
    s_cmp_eq_u32 s71, 0
    s_cbranch_scc1 L_go_30
    s_sleep 6
L_back_31:
    s_mov_b32 m0, s83
    s_mov_b64 exec, 0x77777777
    buffer_load_dword v13, v12, s[56:59], s82 offen sc1
    buffer_load_dwordx4 v12, s[56:59], s82 offen sc1 lds
    s_mov_b64 exec, -1
    v_lshlrev_b32 v60, 7, v0
    s_lshl_b32 s79, s64, 17
    s_lshl_b32 s78, s65, 12
    s_add_u32 s79, s79, s78
    s_lshl_b32 s78, s66, 10
    s_add_u32 s79, s79, s78
    s_mov_b32 exec_lo, 255
    s_mov_b32 exec_hi, 0
    buffer_load_dword v10, v60, s[48:51], s79 offen
    s_mov_b64 exec, -1
    s_lshl_b32 s79, s65, 10
    s_lshl_b32 s78, s66, 8
    s_add_u32 s79, s79, s78
    v_lshl_add_u32 v60, v0, 7, s79
    v_min_u32 v60, L_tailend-L_top_fast, v60
    s_getpc_b64 s[78:79]
L_pc_33:
    s_add_u32 s78, s78, L_top_fast-L_pc_33
    s_addc_u32 s79, s79, -1
    s_mov_b64 exec, 3
    global_load_dword v10, v60, s[78:79]
    s_mov_b64 exec, -1
    s_waitcnt vmcnt(4)
    s_barrier
    ds_read_b64_tr_b16 v[28:29], v52 offset:0
    ds_read_b64_tr_b16 v[30:31], v52 offset:1024
    ds_read_b64_tr_b16 v[32:33], v54 offset:0
    ds_read_b64_tr_b16 v[34:35], v54 offset:1024
    ds_read_b64_tr_b16 v[36:37], v52 offset:2048
    ds_read_b64_tr_b16 v[38:39], v52 offset:3072
    ds_read_b64_tr_b16 v[40:41], v54 offset:2048
    ds_read_b64_tr_b16 v[42:43], v54 offset:3072
    ds_read_b64_tr_b16 v[44:45], v52 offset:4096
    ds_read_b64_tr_b16 v[46:47], v52 offset:5120
    ds_read_b64_tr_b16 v[48:49], v54 offset:4096
    ds_read_b64_tr_b16 v[50:51], v54 offset:5120
    s_waitcnt lgkmcnt(0)
    s_barrier
    s_mov_b32 m0, s68
    s_add_u32 s79, s94, 0
    buffer_load_dwordx4 v8, s[36:39], s79 offen offset:0  lds
    s_add_u32 s79, s94, 31744
    v_xor_b32 v9, 128, v8
    buffer_load_dwordx4 v9, s[36:39], s79 offen offset:1024  lds
    s_add_u32 s79, s94, 63488
    v_xor_b32 v9, 144, v8
    buffer_load_dwordx4 v9, s[36:39], s79 offen offset:2048  lds
    s_add_u32 s79, s94, 95232
    v_xor_b32 v9, 16, v8
    buffer_load_dwordx4 v9, s[36:39], s79 offen offset:3072  lds
    s_waitcnt vmcnt(7)
L_chk_34:
    v_cmp_eq_u32 vcc, -1, v13
    s_waitcnt vmcnt(6)
    s_cbranch_vccnz L_retry_37
L_got_36:
    s_mov_b64 exec, s[84:85]
    s_barrier
    ds_read_b128 v[16:19], v11 offset:0
    ds_read_b128 v[20:23], v11 offset:16
    ds_read_b128 v[24:27], v11 offset:32
    s_mov_b64 exec, -1
    s_waitcnt lgkmcnt(2)
    v_mfma_f32_16x16x32_bf16 v[60:63], v[16:19], v[16:19], 0
    s_waitcnt lgkmcnt(1)
    v_mfma_f32_16x16x32_bf16 v[60:63], v[20:23], v[20:23], v[60:63]
    s_waitcnt lgkmcnt(0)
    v_mfma_f32_16x16x32_bf16 v[60:63], v[24:27], v[24:27], v[60:63]
    v_mfma_f32_16x16x32_bf16 v[52:55], v[16:19], v[28:31], 0
    s_nop 1
    v_mfma_f32_16x16x32_bf16 v[52:55], v[20:23], v[36:39], v[52:55]
    s_nop 1
    v_mfma_f32_16x16x32_bf16 v[52:55], v[24:27], v[44:47], v[52:55]
    s_nop 0
    v_pk_add_f32 v[60:61], v[60:61], v[62:63]
    v_mfma_f32_16x16x32_bf16 v[56:59], v[16:19], v[32:35], 0
    v_add_f32 v62, v60, v61
    v_add_f32 v60, v60, v61
    v_mfma_f32_16x16x32_bf16 v[56:59], v[20:23], v[40:43], v[56:59]
    v_cmp_u_f32 vcc, v62, v62
    v_permlane16_swap_b32 v60, v62
    v_mfma_f32_16x16x32_bf16 v[56:59], v[24:27], v[48:51], v[56:59]
    v_add_f32 v60, v60, v62
    v_pk_add_f32 v[52:53], v[52:53], v[54:55]
    v_add_f32 v52, v52, v53
    v_add_f32_dpp v60, v60, v60 quad_perm:[1,0,3,2] row_mask:0xf bank_mask:0xf
    s_nop 1
    v_add_f32_dpp v60, v60, v60 quad_perm:[2,3,0,1] row_mask:0xf bank_mask:0xf
    s_nop 0
    v_pk_add_f32 v[56:57], v[56:57], v[58:59]
    v_add_f32 v56, v56, v57
    v_add_f32_dpp v60, v60, v60 row_half_mirror row_mask:0xf bank_mask:0xf
    s_cbranch_vccnz L_retry_40
L_got_39:
    v_permlane16_swap_b32 v52, v56
    v_add_f32 v52, v52, v56
    s_nop 1
    v_mov_b32_dpp v53, v52 quad_perm:[1,0,3,2] row_mask:0xf bank_mask:0xf
    v_cvt_pk_bf16_f32 v52, v52, v53
    v_cndmask_b32 v52, v52, v60, s[22:23]
    buffer_store_dword v52, v14, s[52:55], s88 offen
L_back_19:
    s_sub_u32 s78, s68, s69
    v_add_u32 v56, s78, v3
    v_xor_b32 v57, 64, v56
    v_xor_b32 v58, 128, v56
    v_xor_b32 v59, 192, v56
    v_and_b32 v36, 7, v0
    v_lshlrev_b32 v37, 3, v36
    s_mov_b32 vcc_lo, 3233857728
    s_mov_b32 vcc_hi, 3233857728
    v_cndmask_b32 v37, v37, 2.0, vcc
    s_mov_b32 vcc_lo, 4026593280
    s_mov_b32 vcc_hi, 4026593280
    v_cndmask_b32 v33, v6, 2.0, vcc
    s_waitcnt vmcnt(1)
    ds_read_b128 v[40:43], v56
    v_mov_b64 v[16:17], 0
    ds_read_b128 v[44:47], v57
    v_mov_b64 v[18:19], 0
    ds_read_b128 v[48:51], v58
    v_mov_b64 v[20:21], 0
    ds_read_b128 v[52:55], v59
    v_mov_b64 v[22:23], 0
L_poll_47:
    s_cmp_eq_u32 s71, 0
    s_cbranch_scc1 L_cs_48
L_csb_49:
    buffer_load_dwordx2 v[34:35], v37, s[52:55], s5 offen sc1
    buffer_load_dwordx4 v[8:11], v33, s[52:55], s4 offen offset:0 sc1
    buffer_load_dwordx4 v[12:15], v33, s[52:55], s4 offen offset:1024 sc1
    v_mov_b64 v[24:25], 0
    v_mov_b64 v[26:27], 0
    v_mov_b64 v[28:29], 0
    v_mov_b64 v[30:31], 0
    v_and_b32 v38, 8, v0
    v_lshlrev_b32 v38, 3, v38
    v_lshl_or_b32 v38, v36, 1, v38
    s_lshl_b32 s78, s66, 4
    s_add_u32 s78, s78, 154624
    v_add_u32 v38, s78, v38
    v_add_u32 v39, 154624, v6
    v_mov_b32 v32, 0x4575fdf0
    s_cmp_lg_u32 s66, 0
    s_waitcnt vmcnt(3) lgkmcnt(0)
    v_smfmac_f32_16x16x64_bf16 v[28:31], v[16:19], v[40:47], v1
    v_smfmac_f32_16x16x64_bf16 v[28:31], v[20:23], v[48:55], v1
    s_waitcnt vmcnt(2)
    v_cmp_u_f32 vcc, v34, v35
    v_add_f32_dpp v35, v35, v35 row_ror:4 row_mask:0xf bank_mask:0xf
    v_add_f32_dpp v34, v34, v34 row_ror:4 row_mask:0xf bank_mask:0xf
    s_nop 0
    v_add_f32_dpp v35, v35, v35 row_ror:2 row_mask:0xf bank_mask:0xf
    v_add_f32_dpp v34, v34, v34 row_ror:2 row_mask:0xf bank_mask:0xf
    s_cbranch_vccnz L_retry_51
L_got_50:
    s_waitcnt vmcnt(1)
    v_smfmac_f32_16x16x64_bf16 v[24:27], v[8:11], v[40:47], v1
    v_add_f32_dpp v35, v35, v35 row_ror:1 row_mask:0xf bank_mask:0xf
    v_add_f32_dpp v34, v34, v34 row_ror:1 row_mask:0xf bank_mask:0xf
    v_pk_add_f32 v[28:29], v[28:29], v[30:31]
    v_mul_f32 v35, 0x37e38e39, v35
    s_waitcnt vmcnt(0)
    v_smfmac_f32_16x16x64_bf16 v[24:27], v[12:15], v[48:55], v1
    v_mul_f32 v34, 0x37e38e39, v34
    v_add_f32 v28, v28, v29
    v_fma_f32 v34, -v35, v35, v34
    v_max_f32 v34, 0, v34
    v_add_f32 v30, v28, v7
    v_fmaak_f32 v34, v32, v34, 0x3a21369a
    v_rsq_f32 v34, v34
    v_mul_f32 v28, v30, v35
    v_pk_add_f32 v[24:25], v[24:25], v[26:27]
    v_sub_f32 v24, v24, v28
    v_add_f32 v24, v24, v25
    v_mul_f32 v25, v24, v34
    v_mul_f32 v24, v24, v34
    v_cmp_u_f32 vcc, v24, v24
    s_nop 0
    v_permlane32_swap_b32 v24, v25
    v_add_f32 v26, v24, v25
    v_add_f32 v24, v24, v25
    s_nop 1
    v_permlane16_swap_b32 v24, v26
    v_add_f32 v24, v24, v26
    v_cvt_pk_bf16_f32 v24, v24, v24
    ds_write_b16 v38, v24
    s_cbranch_vccnz L_retry_53
L_got_52:
    v_mov_b32 v7, v30
    s_waitcnt lgkmcnt(0)
    s_barrier
    s_cbranch_scc1 L_notw_54
    s_mov_b64 exec, 0xff
    ds_read_b128 v[24:27], v39
    s_waitcnt lgkmcnt(0)
    buffer_store_dwordx4 v[24:27], v6, s[56:59], s6 offen sc1
    s_mov_b64 exec, -1
L_notw_54:
    s_cmp_eq_u32 s74, 3
    s_cbranch_scc1 L_res_55
L_resback_56:
    s_mul_i32 s78, s66, -12288
    s_add_u32 s78, s78, 65536
    v_add_u32 v56, s78, v3
    v_xor_b32 v57, 64, v56
    v_and_b32 v58, 12, v0
    v_lshlrev_b32 v58, 4, v58
    v_and_or_b32 v58, v0, 48, v58
    v_lshlrev_b32 v58, 2, v58
    v_and_or_b32 v58, v6, 48, v58
    v_lshlrev_b32 v8, 7, v0
    v_mov_b32 v9, 0
    v_add_u32 v59, 131072, v6
    s_barrier
    s_cmp_eq_u32 s71, 0
    s_cbranch_scc1 L_go_60
    v_mov_b32 v12, -1
    v_mov_b32 v13, -1
    v_mov_b32 v14, -1
    v_mov_b32 v15, -1
    v_lshrrev_b32 v16, 4, v0
    v_and_b32 v17, 0xf0, v6
    v_lshl_or_b32 v16, v16, 16, v17
    s_add_u32 s79, s8, 0
    buffer_store_dwordx4 v[12:15], v16, s[48:51], s79 offen
    s_add_u32 s79, s8, 4096
    buffer_store_dwordx4 v[12:15], v16, s[48:51], s79 offen
    s_add_u32 s79, s8, 8192
    buffer_store_dwordx4 v[12:15], v16, s[48:51], s79 offen
    s_add_u32 s79, s8, 12288
    buffer_store_dwordx4 v[12:15], v16, s[48:51], s79 offen
    s_sleep 6
L_back_61:
L_poll_66:
    s_mov_b32 m0, s68
    s_mov_b32 exec_lo, 4294967295
    s_mov_b32 exec_hi, 0
    buffer_load_dword v9, v8, s[56:59], s7 offen sc1
    s_mov_b64 exec, -1
    buffer_load_dwordx4 v58, s[56:59], s7 offen offset:0 sc1 lds
    buffer_load_dwordx4 v58, s[56:59], s7 offen offset:1024 sc1 lds
    buffer_load_dwordx4 v58, s[56:59], s7 offen offset:2048 sc1 lds
    buffer_load_dwordx4 v58, s[56:59], s7 offen offset:3072 sc1 lds
    ds_read_b128 v[24:27], v56 offset:0
    ds_read_b128 v[28:31], v57 offset:0
    ds_read_b128 v[32:35], v56 offset:16384
    ds_read_b128 v[36:39], v57 offset:16384
    ds_read_b128 v[40:43], v56 offset:32768
    ds_read_b128 v[44:47], v57 offset:32768
    ds_read_b128 v[48:51], v56 offset:49152
    ds_read_b128 v[52:55], v57 offset:49152
    v_xor_b32 v56, 128, v56
    v_xor_b32 v57, 128, v57
    v_lshrrev_b32 v10, 2, v0
    v_lshlrev_b32 v10, 13, v10
    v_and_or_b32 v10, v6, 48, v10
L_chk_67:
    s_waitcnt vmcnt(4)
    v_cmp_eq_u32 vcc, -1, v9
    s_cbranch_vccnz L_retry_70
L_got_69:
    s_add_u32 s79, s95, 130048
    s_add_u32 s80, s95, 260096
    s_add_u32 s81, s95, 390144
    v_mov_b32 v58, v10
    s_waitcnt vmcnt(2) lgkmcnt(0)
    s_barrier
    ds_read_b128 v[8:11], v59 offset:0
    ds_read_b128 v[12:15], v59 offset:1024
    ds_read_b128 v[16:19], v59 offset:8192
    ds_read_b128 v[20:23], v59 offset:9216
    s_add_u32 m0, s68, 4096
    s_waitcnt lgkmcnt(3)
    v_mfma_f32_16x16x32_bf16 v[60:63], v[24:27], v[8:11], 0
    ds_read_b128 v[24:27], v56 offset:0
    ds_read_b128 v[8:11], v59 offset:16384
    s_waitcnt lgkmcnt(4)
    v_mfma_f32_16x16x32_bf16 v[60:63], v[28:31], v[12:15], v[60:63]
    ds_read_b128 v[28:31], v57 offset:0
    ds_read_b128 v[12:15], v59 offset:17408
    buffer_load_dwordx4 v58, s[40:43], s95 offen offset:0  lds
    s_waitcnt lgkmcnt(5)
    v_mfma_f32_16x16x32_bf16 v[60:63], v[32:35], v[16:19], v[60:63]
    ds_read_b128 v[32:35], v56 offset:16384
    ds_read_b128 v[16:19], v59 offset:24576
    s_waitcnt lgkmcnt(6)
    v_mfma_f32_16x16x32_bf16 v[60:63], v[36:39], v[20:23], v[60:63]
    ds_read_b128 v[36:39], v57 offset:16384
    ds_read_b128 v[20:23], v59 offset:25600
    buffer_load_dwordx4 v58, s[40:43], s79 offen offset:1024  lds
    s_waitcnt lgkmcnt(6)
    v_mfma_f32_16x16x32_bf16 v[60:63], v[40:43], v[8:11], v[60:63]
    ds_read_b128 v[40:43], v56 offset:32768
    s_waitcnt vmcnt(2)
    s_barrier
    ds_read_b128 v[8:11], v59 offset:2048
    s_waitcnt lgkmcnt(6)
    v_mfma_f32_16x16x32_bf16 v[60:63], v[44:47], v[12:15], v[60:63]
    ds_read_b128 v[44:47], v57 offset:32768
    ds_read_b128 v[12:15], v59 offset:3072
    buffer_load_dwordx4 v58, s[40:43], s80 offen offset:2048  lds
    s_waitcnt lgkmcnt(6)
    v_mfma_f32_16x16x32_bf16 v[60:63], v[48:51], v[16:19], v[60:63]
    ds_read_b128 v[48:51], v56 offset:49152
    ds_read_b128 v[16:19], v59 offset:10240
    s_waitcnt lgkmcnt(6)
    v_mfma_f32_16x16x32_bf16 v[60:63], v[52:55], v[20:23], v[60:63]
    ds_read_b128 v[52:55], v57 offset:49152
    ds_read_b128 v[20:23], v59 offset:11264
    buffer_load_dwordx4 v58, s[40:43], s81 offen offset:3072  lds
    s_waitcnt lgkmcnt(6)
    v_mfma_f32_16x16x32_bf16 v[60:63], v[24:27], v[8:11], v[60:63]
    ds_read_b128 v[8:11], v59 offset:18432
    v_and_b32 v27, 0xf0, v6
    s_lshl_b32 s78, s66, 2
    s_waitcnt lgkmcnt(5)
    v_mfma_f32_16x16x32_bf16 v[60:63], v[28:31], v[12:15], v[60:63]
    ds_read_b128 v[12:15], v59 offset:19456
    v_add_u32 v27, 131072, v27
    s_waitcnt lgkmcnt(4)
    v_mfma_f32_16x16x32_bf16 v[60:63], v[32:35], v[16:19], v[60:63]
    ds_read_b128 v[16:19], v59 offset:26624
    s_barrier
    s_waitcnt lgkmcnt(3)
    v_mfma_f32_16x16x32_bf16 v[60:63], v[36:39], v[20:23], v[60:63]
    ds_read_b128 v[20:23], v59 offset:27648
    v_add_u32 v24, s78, v27
    s_waitcnt lgkmcnt(3)
    v_mfma_f32_16x16x32_bf16 v[60:63], v[40:43], v[8:11], v[60:63]
    v_xor_b32 v56, 128, v56
    v_lshl_add_u32 v25, v0, 3, s68
    s_waitcnt lgkmcnt(2)
    v_mfma_f32_16x16x32_bf16 v[60:63], v[44:47], v[12:15], v[60:63]
    v_xor_b32 v57, 65568, v2
    ds_read_b64_tr_b16 v[40:41], v57 offset:0
    s_waitcnt lgkmcnt(2)
    v_mfma_f32_16x16x32_bf16 v[60:63], v[48:51], v[16:19], v[60:63]
    ds_read_b64_tr_b16 v[42:43], v57 offset:4096
    ds_read_b64_tr_b16 v[44:45], v57 offset:8192
    s_waitcnt lgkmcnt(3)
    v_mfma_f32_16x16x32_bf16 v[60:63], v[52:55], v[20:23], v[60:63]
    ds_read_b64_tr_b16 v[46:47], v57 offset:12288
    v_mov_b32 v26, 131072
    v_lshl_add_u32 v26, v0, 3, v26
    v_mov_b32 v36, 0x3f803f80
    v_mov_b32 v37, 0x3f803f80
    v_mov_b32 v38, 0x3f803f80
    v_mov_b32 v39, 0x3f803f80
    s_nop 0
    v_max3_f32 v28, v60, v61, v62
    v_max_f32 v29, v28, v63
    v_max_f32 v28, v28, v63
    v_xor_b32 v57, 65536, v2
    ds_read_b64_tr_b16 v[16:17], v57 offset:0
    v_permlane32_swap_b32 v28, v29
    v_max_f32 v30, v28, v29
    v_max_f32 v28, v28, v29
    ds_read_b64_tr_b16 v[18:19], v57 offset:4096
    ds_read_b64_tr_b16 v[20:21], v57 offset:8192
    v_permlane16_swap_b32 v28, v30
    v_max_f32 v28, v28, v30
    ds_write_b32 v24, v28
    ds_read_b64_tr_b16 v[22:23], v57 offset:12288
    v_xor_b32 v57, 65600, v2
    ds_read_b64_tr_b16 v[48:49], v57 offset:0
    ds_read_b64_tr_b16 v[50:51], v57 offset:4096
    ds_read_b64_tr_b16 v[52:53], v57 offset:8192
    ds_read_b64_tr_b16 v[54:55], v57 offset:12288
    s_waitcnt lgkmcnt(5)
    s_barrier
    ds_read_b128 v[28:31], v27
    s_add_u32 s79, s8, 4096
    s_add_u32 s80, s8, 8192
    s_add_u32 s81, s8, 12288
    s_waitcnt lgkmcnt(0)
    v_max3_f32 v28, v28, v29, v30
    v_max_f32 v28, v28, v31
    v_pk_add_f32 v[60:61], v[60:61], v[28:29] op_sel_hi:[1,0] neg_lo:[0,1] neg_hi:[0,1]
    v_pk_add_f32 v[62:63], v[62:63], v[28:29] op_sel_hi:[1,0] neg_lo:[0,1] neg_hi:[0,1]
    v_exp_f32 v60, v60
    v_exp_f32 v61, v61
    v_exp_f32 v62, v62
    v_exp_f32 v63, v63
    v_cvt_pk_bf16_f32 v30, v60, v61
    v_cvt_pk_bf16_f32 v31, v62, v63
    ds_write_b64 v25, v[30:31] offset:1024
    v_lshrrev_b32 v61, 4, v0
    v_and_b32 v60, 0xf0, v6
    v_lshl_or_b32 v61, v61, 16, v60
    v_mov_b32 v62, v28
    v_xor_b32 v57, 64, v56
    v_and_b32 v27, 12, v0
    v_lshlrev_b32 v27, 2, v27
    s_waitcnt lgkmcnt(0)
    s_barrier
    ds_read2st64_b64 v[8:11], v26 offset0:2 offset1:18
    ds_read2st64_b64 v[12:15], v26 offset0:34 offset1:50
    v_and_or_b32 v27, v0, 3, v27
    v_lshlrev_b32 v27, 5, v27
    v_and_b32 v60, 48, v0
    v_lshl_or_b32 v27, v60, 20, v27
    s_waitcnt lgkmcnt(1)
    v_cmp_u_f32 vcc, v8, v8
    v_mfma_f32_16x16x32_bf16 v[28:31], v[8:11], v[16:19], 0
    v_mfma_f32_16x16x32_bf16 v[32:35], v[36:39], v[8:11], 0
    s_cbranch_vccnz L_retry_73
L_got_72:
    s_waitcnt lgkmcnt(0)
    v_mfma_f32_16x16x32_bf16 v[32:35], v[36:39], v[12:15], v[32:35]
    v_xor_b32 v60, 65632, v2
    ds_read_b64_tr_b16 v[16:17], v60 offset:0
    ds_read_b64_tr_b16 v[18:19], v60 offset:4096
    v_mfma_f32_16x16x32_bf16 v[28:31], v[12:15], v[20:23], v[28:31]
    ds_read_b64_tr_b16 v[20:21], v60 offset:8192
    ds_read_b64_tr_b16 v[22:23], v60 offset:12288
    v_xor_b32 v60, 65664, v2
    v_mfma_f32_16x16x32_bf16 v[56:59], v[8:11], v[40:43], 0
    ds_read_b64_tr_b16 v[40:41], v60 offset:0
    ds_read_b64_tr_b16 v[42:43], v60 offset:4096
    v_mfma_f32_16x16x32_bf16 v[56:59], v[12:15], v[44:47], v[56:59]
    ds_read_b64_tr_b16 v[44:45], v60 offset:8192
    ds_read_b64_tr_b16 v[46:47], v60 offset:12288
    v_mov_b32 v63, v32
    buffer_store_dwordx2 v[62:63], v27, s[52:55], s9 offen
    v_xor_b32 v60, 65696, v2
    v_mfma_f32_16x16x32_bf16 v[36:39], v[8:11], v[48:51], 0
    ds_read_b64_tr_b16 v[48:49], v60 offset:0
    ds_read_b64_tr_b16 v[50:51], v60 offset:4096
    v_mfma_f32_16x16x32_bf16 v[36:39], v[12:15], v[52:55], v[36:39]
    ds_read_b64_tr_b16 v[52:53], v60 offset:8192
    ds_read_b64_tr_b16 v[54:55], v60 offset:12288
    s_waitcnt lgkmcnt(8)
    v_xor_b32 v60, 65728, v2
    v_mfma_f32_16x16x32_bf16 v[32:35], v[8:11], v[16:19], 0
    ds_read_b64_tr_b16 v[16:17], v60 offset:0
    ds_read_b64_tr_b16 v[18:19], v60 offset:4096
    v_cvt_pk_bf16_f32 v24, v28, v56
    v_cvt_pk_bf16_f32 v25, v29, v57
    v_mfma_f32_16x16x32_bf16 v[32:35], v[12:15], v[20:23], v[32:35]
    ds_read_b64_tr_b16 v[20:21], v60 offset:8192
    ds_read_b64_tr_b16 v[22:23], v60 offset:12288
    v_cvt_pk_bf16_f32 v26, v30, v58
    v_cvt_pk_bf16_f32 v27, v31, v59
    s_waitcnt lgkmcnt(8)
    v_xor_b32 v60, 65760, v2
    v_mfma_f32_16x16x32_bf16 v[28:31], v[8:11], v[40:43], 0
    buffer_store_dwordx4 v[24:27], v61, s[48:51], s8 offen
    ds_read_b64_tr_b16 v[40:41], v60 offset:0
    ds_read_b64_tr_b16 v[42:43], v60 offset:4096
    v_mfma_f32_16x16x32_bf16 v[28:31], v[12:15], v[44:47], v[28:31]
    ds_read_b64_tr_b16 v[44:45], v60 offset:8192
    ds_read_b64_tr_b16 v[46:47], v60 offset:12288
    s_waitcnt lgkmcnt(8)
    v_mfma_f32_16x16x32_bf16 v[56:59], v[8:11], v[48:51], 0
    v_cvt_pk_bf16_f32 v24, v36, v32
    v_cvt_pk_bf16_f32 v25, v37, v33
    v_mfma_f32_16x16x32_bf16 v[56:59], v[12:15], v[52:55], v[56:59]
    v_cvt_pk_bf16_f32 v26, v38, v34
    v_cvt_pk_bf16_f32 v27, v39, v35
    s_waitcnt lgkmcnt(4)
    v_mfma_f32_16x16x32_bf16 v[36:39], v[8:11], v[16:19], 0
    buffer_store_dwordx4 v[24:27], v61, s[48:51], s79 offen
    v_lshlrev_b32 v60, 3, v0
    v_mfma_f32_16x16x32_bf16 v[36:39], v[12:15], v[20:23], v[36:39]
    s_waitcnt lgkmcnt(0)
    v_mfma_f32_16x16x32_bf16 v[32:35], v[8:11], v[40:43], 0
    v_cvt_pk_bf16_f32 v24, v28, v56
    v_cvt_pk_bf16_f32 v25, v29, v57
    v_cvt_pk_bf16_f32 v26, v30, v58
    v_cvt_pk_bf16_f32 v27, v31, v59
    v_mfma_f32_16x16x32_bf16 v[32:35], v[12:15], v[44:47], v[32:35]
    buffer_store_dwordx4 v[24:27], v61, s[48:51], s80 offen
    s_nop 6
    v_cvt_pk_bf16_f32 v24, v36, v32
    v_cvt_pk_bf16_f32 v25, v37, v33
    v_cvt_pk_bf16_f32 v26, v38, v34
    v_cvt_pk_bf16_f32 v27, v39, v35
    buffer_store_dwordx4 v[24:27], v61, s[48:51], s81 offen
    buffer_load_dwordx2 v[22:23], v60, s[52:55], s11 offen sc1
    v_and_b32 v45, 56, v0
    v_lshlrev_b32 v45, 1, v45
    v_and_or_b32 v45, v0, 6, v45
    v_lshlrev_b32 v45, 1, v45
    v_and_or_b32 v45, v6, 16, v45
    v_lshlrev_b32 v46, 2, v0
    s_mov_b32 vcc_lo, 0
    s_mov_b32 vcc_hi, 4294967295
    v_cndmask_b32 v46, v46, 2.0, vcc
    v_mov_b64 v[28:29], 0
    v_mov_b64 v[30:31], 0
    v_mov_b64 v[32:33], 0
    v_mov_b64 v[34:35], 0
    s_waitcnt vmcnt(0)
L_chk_74:
    v_cmp_u_f32 vcc, v22, v23
    v_max_f32_dpp v36, v22, v22 quad_perm:[1,0,3,2] row_mask:0xf bank_mask:0xf
    v_mov_b64 v[24:25], v[22:23]
    s_cbranch_vccnz L_retry_77
L_got_76:
    v_max_f32_dpp v37, v36, v36 quad_perm:[2,3,0,1] row_mask:0xf bank_mask:0xf
    v_max_f32_dpp v36, v36, v36 quad_perm:[2,3,0,1] row_mask:0xf bank_mask:0xf
    s_nop 1
    v_permlane32_swap_b32 v36, v37
    v_max_f32 v38, v36, v37
    v_max_f32 v36, v36, v37
    s_nop 1
    v_permlane16_swap_b32 v36, v38
    v_max_f32 v36, v36, v38
    buffer_load_dwordx4 v[8:11], v6, s[48:51], s10 offen offset:0 sc1
    buffer_load_dwordx4 v[12:15], v6, s[48:51], s10 offen offset:1024 sc1
    buffer_load_dwordx4 v[16:19], v6, s[48:51], s10 offen offset:2048 sc1
    buffer_load_dwordx4 v[20:23], v6, s[48:51], s10 offen offset:3072 sc1
    v_sub_f32 v24, v24, v36
    v_exp_f32 v24, v24
    s_nop 0
    v_mul_f32 v25, v25, v24
    s_nop 1
    v_add_f32_dpp v25, v25, v25 quad_perm:[1,0,3,2] row_mask:0xf bank_mask:0xf
    s_nop 1
    v_add_f32_dpp v37, v25, v25 quad_perm:[2,3,0,1] row_mask:0xf bank_mask:0xf
    v_add_f32_dpp v25, v25, v25 quad_perm:[2,3,0,1] row_mask:0xf bank_mask:0xf
    s_nop 1
    v_permlane32_swap_b32 v25, v37
    v_add_f32 v38, v25, v37
    v_add_f32 v25, v25, v37
    s_nop 1
    v_permlane16_swap_b32 v25, v38
    v_add_f32 v25, v25, v38
    v_rcp_f32 v38, v25
    v_log_f32 v37, v25
    v_mul_f32 v24, v24, v38
    v_add_f32 v37, v37, v36
    v_cvt_pk_bf16_f32 v26, v24, 0
    v_cvt_pk_bf16_f32 v27, 0, v24
    buffer_store_dword v37, v46, s[56:59], s13 offen sc1
L_acc_78:
    s_waitcnt vmcnt(4)
    v_dot2c_f32_bf16_dpp v28, v26, v8 row_newbcast:0 row_mask:0xf bank_mask:0xf
    v_dot2c_f32_bf16_dpp v29, v27, v8 row_newbcast:0 row_mask:0xf bank_mask:0xf
    v_dot2c_f32_bf16_dpp v30, v26, v9 row_newbcast:4 row_mask:0xf bank_mask:0xf
    v_dot2c_f32_bf16_dpp v31, v27, v9 row_newbcast:4 row_mask:0xf bank_mask:0xf
    v_dot2c_f32_bf16_dpp v32, v26, v10 row_newbcast:8 row_mask:0xf bank_mask:0xf
    v_dot2c_f32_bf16_dpp v33, v27, v10 row_newbcast:8 row_mask:0xf bank_mask:0xf
    v_dot2c_f32_bf16_dpp v34, v26, v11 row_newbcast:12 row_mask:0xf bank_mask:0xf
    v_dot2c_f32_bf16_dpp v35, v27, v11 row_newbcast:12 row_mask:0xf bank_mask:0xf
    s_waitcnt vmcnt(3)
    v_dot2c_f32_bf16_dpp v28, v26, v12 row_newbcast:1 row_mask:0xf bank_mask:0xf
    v_dot2c_f32_bf16_dpp v29, v27, v12 row_newbcast:1 row_mask:0xf bank_mask:0xf
    v_dot2c_f32_bf16_dpp v30, v26, v13 row_newbcast:5 row_mask:0xf bank_mask:0xf
    v_dot2c_f32_bf16_dpp v31, v27, v13 row_newbcast:5 row_mask:0xf bank_mask:0xf
    v_dot2c_f32_bf16_dpp v32, v26, v14 row_newbcast:9 row_mask:0xf bank_mask:0xf
    v_dot2c_f32_bf16_dpp v33, v27, v14 row_newbcast:9 row_mask:0xf bank_mask:0xf
    v_dot2c_f32_bf16_dpp v34, v26, v15 row_newbcast:13 row_mask:0xf bank_mask:0xf
    v_dot2c_f32_bf16_dpp v35, v27, v15 row_newbcast:13 row_mask:0xf bank_mask:0xf
    s_waitcnt vmcnt(2)
    v_dot2c_f32_bf16_dpp v28, v26, v16 row_newbcast:2 row_mask:0xf bank_mask:0xf
    v_dot2c_f32_bf16_dpp v29, v27, v16 row_newbcast:2 row_mask:0xf bank_mask:0xf
    v_dot2c_f32_bf16_dpp v30, v26, v17 row_newbcast:6 row_mask:0xf bank_mask:0xf
    v_dot2c_f32_bf16_dpp v31, v27, v17 row_newbcast:6 row_mask:0xf bank_mask:0xf
    v_dot2c_f32_bf16_dpp v32, v26, v18 row_newbcast:10 row_mask:0xf bank_mask:0xf
    v_dot2c_f32_bf16_dpp v33, v27, v18 row_newbcast:10 row_mask:0xf bank_mask:0xf
    v_dot2c_f32_bf16_dpp v34, v26, v19 row_newbcast:14 row_mask:0xf bank_mask:0xf
    v_dot2c_f32_bf16_dpp v35, v27, v19 row_newbcast:14 row_mask:0xf bank_mask:0xf
    s_waitcnt vmcnt(1)
    v_dot2c_f32_bf16_dpp v28, v26, v20 row_newbcast:3 row_mask:0xf bank_mask:0xf
    v_dot2c_f32_bf16_dpp v29, v27, v20 row_newbcast:3 row_mask:0xf bank_mask:0xf
    v_dot2c_f32_bf16_dpp v30, v26, v21 row_newbcast:7 row_mask:0xf bank_mask:0xf
    v_dot2c_f32_bf16_dpp v31, v27, v21 row_newbcast:7 row_mask:0xf bank_mask:0xf
    v_dot2c_f32_bf16_dpp v32, v26, v22 row_newbcast:11 row_mask:0xf bank_mask:0xf
    v_dot2c_f32_bf16_dpp v33, v27, v22 row_newbcast:11 row_mask:0xf bank_mask:0xf
    v_dot2c_f32_bf16_dpp v34, v26, v23 row_newbcast:15 row_mask:0xf bank_mask:0xf
    v_dot2c_f32_bf16_dpp v35, v27, v23 row_newbcast:15 row_mask:0xf bank_mask:0xf
    v_permlane32_swap_b32 v28, v32
    v_permlane32_swap_b32 v29, v33
    v_permlane32_swap_b32 v30, v34
    v_permlane32_swap_b32 v31, v35
    v_pk_add_f32 v[28:29], v[28:29], v[32:33]
    v_pk_add_f32 v[30:31], v[30:31], v[34:35]
    v_cmp_u_f32 vcc, v28, v30
    s_nop 0
    v_permlane16_swap_b32 v28, v30
    v_permlane16_swap_b32 v29, v31
    v_pk_add_f32 v[28:29], v[28:29], v[30:31]
    v_cvt_pk_bf16_f32 v28, v28, v29
    s_cbranch_vccnz L_retry_81
L_got_80:
    buffer_store_dword v28, v45, s[56:59], s12 offen sc1
    v_and_b32 v40, 4, v0
    v_lshlrev_b32 v40, 4, v40
    v_and_or_b32 v40, v0, 48, v40
    v_lshlrev_b32 v40, 1, v40
    v_and_or_b32 v40, v0, 11, v40
    v_lshl_add_u32 v40, v40, 3, s68
    ds_read_b64_tr_b16 v[48:49], v40 offset:4096
    ds_read_b64_tr_b16 v[50:51], v40 offset:4224
    ds_read_b64_tr_b16 v[52:53], v40 offset:6144
    ds_read_b64_tr_b16 v[54:55], v40 offset:6272
    ds_read_b64_tr_b16 v[56:57], v40 offset:4128
    ds_read_b64_tr_b16 v[58:59], v40 offset:4256
    ds_read_b64_tr_b16 v[60:61], v40 offset:6176
    ds_read_b64_tr_b16 v[62:63], v40 offset:6304
    v_lshrrev_b32 v41, 2, v0
    v_mul_u32_u24 v41, 1152, v41
    v_and_or_b32 v41, v6, 48, v41
    s_mov_b32 vcc_lo, 2290649224
    s_mov_b32 vcc_hi, 2290649224
    v_cndmask_b32 v41, v41, 2.0, vcc
    s_waitcnt lgkmcnt(0)
    s_barrier
    s_add_u32 m0, s68, 0
    s_add_u32 s83, s93, 0
    buffer_load_dwordx4 v41, s[44:47], s83 offen offset:0 lds
    s_add_u32 s83, s93, 17408
    buffer_load_dwordx4 v41, s[44:47], s83 offen offset:1024 lds
    s_add_u32 s83, s93, 34816
    buffer_load_dwordx4 v41, s[44:47], s83 offen offset:2048 lds
    s_add_u32 s83, s93, 52224
    buffer_load_dwordx4 v41, s[44:47], s83 offen offset:3072 lds
    s_add_u32 m0, s68, 4096
    s_add_u32 s83, s93, 73728
    buffer_load_dwordx4 v41, s[44:47], s83 offen offset:0 lds
    s_cmp_eq_u32 s71, 0
    s_cbranch_scc1 L_go_82
    s_sleep 1
L_back_83:
    v_lshrrev_b32 v28, 1, v0
    v_and_or_b32 v28, v28, 16, 0
    v_and_or_b32 v28, v0, 14, v28
    v_lshlrev_b32 v28, 6, v28
    v_and_or_b32 v28, v0, 16, v28
    v_lshlrev_b32 v28, 1, v28
    v_and_or_b32 v28, v6, 16, v28
    v_and_b32 v29, 56, v0
    v_lshlrev_b32 v29, 4, v29
    v_lshlrev_b32 v30, 3, v0
    v_and_b32 v30, 16, v30
    v_and_or_b32 v30, v0, 12, v30
    v_and_b32 v31, 32, v0
    v_lshl_or_b32 v30, v31, 3, v30
    s_mov_b32 vcc_lo, 4294945450
    s_mov_b32 vcc_hi, 4294945450
    v_cndmask_b32 v30, v30, 2.0, vcc
    s_lshl_b32 s79, s65, 10
    s_lshl_b32 s78, s66, 8
    s_add_u32 s79, s79, s78
    v_lshl_add_u32 v12, v0, 7, s79
    v_min_u32 v12, L_tailend-L_top_fast, v12
    s_getpc_b64 s[78:79]
L_pc_85:
    s_add_u32 s78, s78, L_top_fast-L_pc_85
    s_addc_u32 s79, s79, -1
    s_mov_b64 exec, 3
    global_load_dword v13, v12, s[78:79]
    s_mov_b64 exec, -1
    s_waitcnt lgkmcnt(0)
    s_sleep 1
    buffer_load_dword v16, v29, s[56:59], s15 offen sc1
    s_sleep 3
    buffer_load_dwordx4 v[8:11], v28, s[56:59], s14 offen sc1
    v_mov_b64 v[20:21], 0
    v_mov_b64 v[22:23], 0
    v_mov_b64 v[24:25], 0
    v_mov_b64 v[26:27], 0
    s_add_u32 m0, s68, 4096
    s_add_u32 s83, s93, 91136
    buffer_load_dwordx4 v41, s[44:47], s83 offen offset:1024 lds
    s_add_u32 s83, s93, 108544
    buffer_load_dwordx4 v41, s[44:47], s83 offen offset:2048 lds
    s_add_u32 s83, s93, 125952
    buffer_load_dwordx4 v41, s[44:47], s83 offen offset:3072 lds
    s_waitcnt vmcnt(4)
L_chk_86:
    v_cmp_eq_u32 vcc, -1, v16
    v_max_f32_dpp v12, v16, v16 row_ror:8 row_mask:0xf bank_mask:0xf
    v_max_f32_dpp v17, v16, v16 row_ror:8 row_mask:0xf bank_mask:0xf
    s_nop 1
    v_permlane32_swap_b32 v17, v12
    v_max_f32 v14, v17, v12
    v_max_f32 v17, v17, v12
    s_cbranch_vccnz L_retry_89
L_got_88:
    s_nop 0
    v_permlane16_swap_b32 v17, v14
    v_max_f32 v17, v17, v14
    v_sub_f32 v16, v16, v17
    v_exp_f32 v16, v16
    s_nop 1
    v_add_f32_dpp v12, v16, v16 row_ror:8 row_mask:0xf bank_mask:0xf
    v_add_f32_dpp v17, v16, v16 row_ror:8 row_mask:0xf bank_mask:0xf
    s_nop 1
    v_permlane32_swap_b32 v17, v12
    v_add_f32 v14, v17, v12
    v_add_f32 v17, v17, v12
    s_nop 1
    v_permlane16_swap_b32 v17, v14
    v_add_f32 v17, v17, v14
    v_rcp_f32 v17, v17
    s_nop 1
    v_mul_f32_dpp v18, v16, v17 row_newbcast:0 row_mask:0xf bank_mask:0xf
    v_mul_f32_dpp v19, v16, v17 row_newbcast:8 row_mask:0xf bank_mask:0xf
    s_waitcnt vmcnt(3)
L_chk_87:
    v_cmp_u_f32 vcc, v8, v8
    v_smfmac_f32_16x16x64_bf16 v[20:23], v[8:11], v[48:55], v1
    v_smfmac_f32_16x16x64_bf16 v[24:27], v[8:11], v[56:63], v1
    s_cbranch_vccnz L_retry_91
L_got_90:
    s_nop 5
    v_pk_mul_f32 v[20:21], v[20:21], v[18:19] op_sel_hi:[1,0]
    v_pk_fma_f32 v[20:21], v[22:23], v[18:19], v[20:21] op_sel:[0,1,0] op_sel_hi:[1,1,1]
    v_pk_mul_f32 v[24:25], v[24:25], v[18:19] op_sel_hi:[1,0]
    v_add_f32 v20, v20, v21
    v_pk_fma_f32 v[24:25], v[26:27], v[18:19], v[24:25] op_sel:[0,1,0] op_sel_hi:[1,1,1]
    v_add_f32 v24, v24, v25
    v_cmp_u_f32 vcc, v20, v20
    s_nop 0
    v_permlane32_swap_b32 v20, v24
    v_add_f32 v21, v20, v24
    v_add_f32 v20, v20, v24
    s_nop 1
    v_permlane16_swap_b32 v20, v21
    v_add_f32 v20, v20, v21
    s_cbranch_vccnz L_retry_93
L_got_92:
    s_nop 0
    v_mov_b32_dpp v21, v20 quad_perm:[1,0,3,2] row_mask:0xf bank_mask:0xf
    v_cvt_pk_bf16_f32 v20, v20, v21
    buffer_store_dword v20, v30, s[52:55], s16 offen
    s_cmp_ge_u32 s65, 24
    s_cbranch_scc1 L_go_94
    s_add_u32 s82, s21, 8192
    v_lshrrev_b32 v28, 4, v0
    v_bfe_u32 v29, v0, 2, 2
    v_lshl_add_u32 v28, v28, 3, v29
    v_mul_u32_u24 v28, 64, v28
    v_and_b32 v29, 3, v0
    v_lshl_add_u32 v28, v29, 3, v28
    v_add_u32 v28, s68, v28
    s_lshl_b32 s80, s66, 3
    s_add_u32 s80, s80, 146432
    s_waitcnt vmcnt(1)
    ds_read_b64_tr_b16 v[32:33], v28 offset:0
    ds_read_b64_tr_b16 v[34:35], v28 offset:256
    ds_read_b64_tr_b16 v[36:37], v28 offset:2048
    ds_read_b64_tr_b16 v[38:39], v28 offset:2304
    ds_read_b64_tr_b16 v[48:49], v28 offset:32
    ds_read_b64_tr_b16 v[50:51], v28 offset:288
    ds_read_b64_tr_b16 v[52:53], v28 offset:2080
    ds_read_b64_tr_b16 v[54:55], v28 offset:2336
    buffer_load_dwordx4 v[8:11], v6, s[52:55], s82 offen sc1
    buffer_load_dwordx4 v[12:15], v6, s[52:55], s82 offen offset:1024 sc1
    ds_read_b64_tr_b16 v[40:41], v28 offset:4096
    v_and_b32 v18, 15, v0
    ds_read_b64_tr_b16 v[42:43], v28 offset:4352
    v_lshrrev_b32 v19, 5, v0
    ds_read_b64_tr_b16 v[44:45], v28 offset:6144
    v_lshl_add_u32 v18, v19, 4, v18
    ds_read_b64_tr_b16 v[46:47], v28 offset:6400
    v_bfe_u32 v19, v0, 4, 1
    ds_read_b64_tr_b16 v[56:57], v28 offset:4128
    v_lshlrev_b32 v19, 2, v19
    ds_read_b64_tr_b16 v[58:59], v28 offset:4384
    v_lshl_add_u32 v18, v18, 5, v19
    ds_read_b64_tr_b16 v[60:61], v28 offset:6176
    v_add_u32 v18, s80, v18
    ds_read_b64_tr_b16 v[62:63], v28 offset:6432
    v_mov_b32 v19, 146432
    v_and_b32 v29, 15, v0
    v_lshl_add_u32 v19, v29, 6, v19
    v_lshlrev_b32 v29, 2, v0
    s_add_u32 s80, s96, 24576
    v_lshrrev_b32 v28, 4, v0
    v_lshlrev_b32 v17, 5, v28
    v_xor_b32 v17, v17, v6
    s_lshl_b32 s79, s66, 7
    v_xor_b32 v17, s79, v17
    v_and_b32 v17, 0xf0, v17
    v_lshl_or_b32 v17, v28, 13, v17
    s_waitcnt lgkmcnt(0)
    s_barrier
L_poll_96:
    buffer_load_dwordx4 v[8:11], v6, s[52:55], s82 offen sc1
    buffer_load_dwordx4 v[12:15], v6, s[52:55], s82 offen offset:1024 sc1
    v_mov_b64 v[26:27], 0
    v_mov_b64 v[24:25], 0
    v_mov_b64 v[22:23], 0
    v_mov_b64 v[20:21], 0
    s_waitcnt vmcnt(2) lgkmcnt(0)
    v_cmp_u_f32 vcc, v8, v12
    v_smfmac_f32_16x16x64_bf16 v[20:23], v[8:11], v[32:39], v1
    v_smfmac_f32_16x16x64_bf16 v[20:23], v[12:15], v[40:47], v1
    s_cbranch_vccnz L_retry_98
L_got_97:
    v_smfmac_f32_16x16x64_bf16 v[24:27], v[8:11], v[48:55], v1
    v_smfmac_f32_16x16x64_bf16 v[24:27], v[12:15], v[56:63], v1
    s_nop 4
    v_pk_add_f32 v[20:21], v[20:21], v[22:23]
    v_add_f32 v20, v20, v21
    v_cmp_u_f32 vcc, v20, v20
    v_pk_add_f32 v[24:25], v[24:25], v[26:27]
    v_add_f32 v24, v24, v25
    s_nop 1
    v_permlane32_swap_b32 v20, v24
    v_add_f32 v20, v20, v24
    ds_write_b32 v18, v20
    s_cbranch_vccnz L_retry_100
L_got_99:
    s_bitcmp0_b32 s74, 0
    s_waitcnt vmcnt(0) lgkmcnt(0)
    s_barrier
    s_cbranch_scc1 L_noy_101
    ds_read_b128 v[32:35], v19 offset:0
    ds_read_b128 v[36:39], v19 offset:16
    ds_read_b128 v[40:43], v19 offset:32
    ds_read_b128 v[44:47], v19 offset:48
    s_mov_b32 exec_hi, 0
    s_waitcnt lgkmcnt(2)
    v_pk_add_f32 v[32:33], v[32:33], v[34:35]
    v_pk_add_f32 v[36:37], v[36:37], v[38:39]
    v_pk_add_f32 v[32:33], v[32:33], v[36:37]
    v_add_f32 v32, v32, v33
    s_waitcnt lgkmcnt(0)
    v_pk_add_f32 v[40:41], v[40:41], v[42:43]
    v_pk_add_f32 v[44:45], v[44:45], v[46:47]
    v_pk_add_f32 v[40:41], v[40:41], v[44:45]
    v_add_f32 v33, v40, v41
    v_pk_add_f32 v[32:33], v[32:33], v[4:5]
    v_cvt_pk_bf16_f32 v34, v32, v33
    buffer_store_dword v34, v29, s[56:59], s80 offen sc1
    s_mov_b32 exec_hi, -1
L_noy_101:
    s_cmp_eq_u32 s71, 1
    s_cbranch_scc1 L_final_fast
    s_add_u32 s52, s52, 73728
    s_addc_u32 s53, s53, 0
    s_mov_b32 s54, 57344
    s_mov_b32 s71, 1
    s_add_u32 m0, s68, 0
    s_add_u32 s79, s92, 0
    buffer_load_dwordx4 v17, s[24:27], s79 offen offset:0 nt lds
    s_add_u32 s79, s92, 31744
    buffer_load_dwordx4 v17, s[24:27], s79 offen offset:1024 nt lds
    s_add_u32 s79, s92, 63488
    buffer_load_dwordx4 v17, s[24:27], s79 offen offset:2048 nt lds
    s_add_u32 m0, s68, 3072
    s_add_u32 s79, s92, 98304
    buffer_load_dwordx4 v17, s[24:27], s79 offen offset:0 nt lds
    s_add_u32 s79, s92, 130048
    buffer_load_dwordx4 v17, s[24:27], s79 offen offset:1024 nt lds
    s_add_u32 s79, s92, 161792
    buffer_load_dwordx4 v17, s[24:27], s79 offen offset:2048 nt lds
    s_barrier
    s_cmp_eq_u32 s74, 3
    s_cselect_b64 vcc, -1, 0
    v_lshlrev_b32 v36, 16, v34
    v_and_b32 v37, 0xffff0000, v34
    v_pk_add_f32 v[32:33], v[32:33], v[36:37] neg_lo:[0,1] neg_hi:[0,1]
    v_cndmask_b32 v4, 0, v32, vcc
    v_cndmask_b32 v5, 0, v33, vcc
    v_mov_b32 v53, 0x3f803f80
    s_lshl_b64 s[82:83], s[84:85], 8
    v_cndmask_b32 v16, 0, v53, s[82:83]
    v_mov_b32 v17, v16
    v_mov_b64 v[18:19], v[16:17]
    v_mov_b64 v[20:21], v[16:17]
    v_mov_b64 v[22:23], v[16:17]
    v_mov_b64 v[24:25], v[16:17]
    v_mov_b64 v[26:27], v[16:17]
    v_lshrrev_b32 v12, 2, v0
    v_mul_u32_u24 v12, 3072, v12
    v_and_or_b32 v12, v6, 48, v12
    s_add_u32 s82, s86, 24576
    s_add_u32 s83, s68, 6144
    v_lshrrev_b32 v52, 4, v0
    v_bfe_u32 v53, v0, 2, 2
    v_lshl_add_u32 v52, v52, 5, v53
    v_and_b32 v53, 31, v0
    v_lshlrev_b32 v53, 3, v53
    v_lshl_or_b32 v52, v52, 8, v53
    s_lshl_b32 s78, s66, 6
    s_add_u32 s78, s78, 131072
    v_xor_b32 v52, s78, v52
    v_xor_b32 v54, 32, v52
    v_and_b32 v14, 31, v0
    v_lshlrev_b32 v14, 2, v14
    v_lshrrev_b32 v15, 1, v0
    s_mov_b32 vcc_lo, 0
    s_mov_b32 vcc_hi, 4294967295
    v_cndmask_b32 v14, v14, 2.0, vcc
    s_sub_u32 s78, s89, s87
    v_writelane_b32 v14, s78, 32
    s_add_u32 s78, s78, 4
    v_writelane_b32 v14, s78, 40
    s_mov_b64 s[22:23], 0x202
    v_and_b32 v11, 48, v0
    v_lshlrev_b32 v11, 3, v11
    v_and_or_b32 v11, v0, 7, v11
    v_lshlrev_b32 v11, 6, v11
    v_add_u32 v11, 137216, v11
    v_mov_b32 v13, 0
    s_sleep 6
    s_mov_b32 m0, s83
    s_mov_b64 exec, 0x77777777
    buffer_load_dword v13, v12, s[56:59], s82 offen sc1
    buffer_load_dwordx4 v12, s[56:59], s82 offen sc1 lds
    s_mov_b64 exec, -1
    v_lshlrev_b32 v60, 7, v0
    s_lshl_b32 s79, s64, 17
    s_lshl_b32 s78, s65, 12
    s_add_u32 s79, s79, s78
    s_lshl_b32 s78, s66, 10
    s_add_u32 s79, s79, s78
    s_mov_b32 exec_lo, 255
    s_mov_b32 exec_hi, 0
    buffer_load_dword v10, v60, s[48:51], s79 offen
    s_mov_b64 exec, -1
    s_waitcnt vmcnt(3)
    s_barrier
    ds_read_b64_tr_b16 v[28:29], v52 offset:0
    ds_read_b64_tr_b16 v[30:31], v52 offset:1024
    ds_read_b64_tr_b16 v[32:33], v54 offset:0
    ds_read_b64_tr_b16 v[34:35], v54 offset:1024
    ds_read_b64_tr_b16 v[36:37], v52 offset:2048
    ds_read_b64_tr_b16 v[38:39], v52 offset:3072
    ds_read_b64_tr_b16 v[40:41], v54 offset:2048
    ds_read_b64_tr_b16 v[42:43], v54 offset:3072
    ds_read_b64_tr_b16 v[44:45], v52 offset:4096
    ds_read_b64_tr_b16 v[46:47], v52 offset:5120
    ds_read_b64_tr_b16 v[48:49], v54 offset:4096
    ds_read_b64_tr_b16 v[50:51], v54 offset:5120
    s_waitcnt lgkmcnt(0)
    s_barrier
    s_waitcnt vmcnt(2)
L_chk_102:
    v_cmp_eq_u32 vcc, -1, v13
    s_waitcnt vmcnt(1)
    s_cbranch_vccnz L_retry_105
L_got_104:
    s_mov_b64 exec, s[84:85]
    s_barrier
    ds_read_b128 v[16:19], v11 offset:0
    ds_read_b128 v[20:23], v11 offset:16
    ds_read_b128 v[24:27], v11 offset:32
    s_mov_b64 exec, -1
    s_waitcnt lgkmcnt(2)
    v_mfma_f32_16x16x32_bf16 v[60:63], v[16:19], v[16:19], 0
    s_waitcnt lgkmcnt(1)
    v_mfma_f32_16x16x32_bf16 v[60:63], v[20:23], v[20:23], v[60:63]
    s_waitcnt lgkmcnt(0)
    v_mfma_f32_16x16x32_bf16 v[60:63], v[24:27], v[24:27], v[60:63]
    v_mfma_f32_16x16x32_bf16 v[52:55], v[16:19], v[28:31], 0
    s_nop 1
    v_mfma_f32_16x16x32_bf16 v[52:55], v[20:23], v[36:39], v[52:55]
    s_nop 1
    v_mfma_f32_16x16x32_bf16 v[52:55], v[24:27], v[44:47], v[52:55]
    s_nop 0
    v_pk_add_f32 v[60:61], v[60:61], v[62:63]
    v_mfma_f32_16x16x32_bf16 v[56:59], v[16:19], v[32:35], 0
    v_add_f32 v62, v60, v61
    v_add_f32 v60, v60, v61
    v_mfma_f32_16x16x32_bf16 v[56:59], v[20:23], v[40:43], v[56:59]
    v_cmp_u_f32 vcc, v62, v62
    v_permlane16_swap_b32 v60, v62
    v_mfma_f32_16x16x32_bf16 v[56:59], v[24:27], v[48:51], v[56:59]
    v_add_f32 v60, v60, v62
    v_pk_add_f32 v[52:53], v[52:53], v[54:55]
    v_add_f32 v52, v52, v53
    v_add_f32_dpp v60, v60, v60 quad_perm:[1,0,3,2] row_mask:0xf bank_mask:0xf
    s_nop 1
    v_add_f32_dpp v60, v60, v60 quad_perm:[2,3,0,1] row_mask:0xf bank_mask:0xf
    s_nop 0
    v_pk_add_f32 v[56:57], v[56:57], v[58:59]
    v_add_f32 v56, v56, v57
    v_add_f32_dpp v60, v60, v60 row_half_mirror row_mask:0xf bank_mask:0xf
    s_cbranch_vccnz L_retry_108
L_got_107:
    v_permlane16_swap_b32 v52, v56
    v_add_f32 v52, v52, v56
    s_nop 1
    v_permlane32_swap_b32 v52, v60
    buffer_store_dword v52, v14, s[52:55], s87 offen
L_back_95:
    v_and_b32 v44, 4, v0
    v_lshlrev_b32 v44, 3, v44
    v_and_b32 v45, 3, v0
    v_lshl_or_b32 v44, v45, 2, v44
    v_lshrrev_b32 v45, 5, v0
    v_lshl_or_b32 v44, v45, 4, v44
    v_bfe_u32 v45, v0, 4, 1
    v_lshl_or_b32 v44, v45, 1, v44
    s_lshl_b32 s78, s66, 6
    s_add_u32 s78, s78, 154624
    v_add_u32 v44, s78, v44
    v_and_b32 v45, 7, v0
    v_lshlrev_b32 v45, 3, v45
    s_mov_b32 vcc_lo, 3233857728
    s_mov_b32 vcc_hi, 3233857728
    v_cndmask_b32 v45, v45, 2.0, vcc
    s_mov_b32 vcc_lo, 0
    s_mov_b32 vcc_hi, 4294901760
    v_cndmask_b32 v47, v6, 2.0, vcc
    v_and_b32 v46, 48, v0
    v_lshlrev_b32 v46, 1, v46
    v_and_or_b32 v46, v6, 16, v46
    v_add_u32 v46, 154624, v46
    s_sleep 1
    buffer_load_dwordx2 v[12:13], v45, s[52:55], s91 offen sc1
    buffer_load_dwordx4 v[8:11], v47, s[52:55], s90 offen sc1
    v_mov_b64 v[20:21], 0
    v_lshl_add_u32 v17, v0, 3, s68
    ds_write_b64 v17, v[20:21] offset:6656
    s_add_u32 s78, s68, 6656
    v_mov_b32 v17, s78
    s_mov_b32 s22, 196611
    s_mov_b32 s23, 196611
    v_cndmask_b32 v56, v17, v46, s[22:23]
    s_lshl_b64 s[22:23], s[22:23], 4
    v_cndmask_b32 v57, v17, v46, s[22:23]
    s_lshl_b64 s[22:23], s[22:23], 4
    v_cndmask_b32 v58, v17, v46, s[22:23]
    s_lshl_b64 s[22:23], s[22:23], 4
    v_cndmask_b32 v59, v17, v46, s[22:23]
    s_lshl_b64 s[22:23], s[22:23], 4
    v_and_b32 v60, 0x32, v0
    v_lshlrev_b32 v60, 3, v60
    v_and_b32 v17, 8, v0
    v_lshl_or_b32 v60, v17, 2, v60
    v_and_b32 v17, 5, v0
    v_lshl_or_b32 v60, v17, 1, v60
    v_add_u32 v60, s68, v60
    v_add_u32 v61, 0, v0
    v_mul_u32_u24 v17, 21846, v61
    v_lshrrev_b32 v17, 16, v17
    v_mul_u32_u24 v17, 1104, v17
    v_lshl_add_u32 v61, v0, 4, v17
    v_add_u32 v62, 64, v0
    v_mul_u32_u24 v17, 21846, v62
    v_lshrrev_b32 v17, 16, v17
    v_mul_u32_u24 v17, 1104, v17
    v_lshl_add_u32 v62, v0, 4, v17
    v_add_u32 v63, 128, v0
    v_mul_u32_u24 v17, 21846, v63
    v_lshrrev_b32 v17, 16, v17
    v_mul_u32_u24 v17, 1104, v17
    v_lshl_add_u32 v63, v0, 4, v17
    s_add_u32 s83, s93, 73728
    v_mov_b64 v[16:17], 0
    v_mov_b64 v[24:25], 0
    v_mov_b64 v[28:29], 0
    v_mov_b32 v39, 0x4575fdf0
L_poll_110:
    buffer_load_dwordx2 v[12:13], v45, s[52:55], s91 offen sc1
    buffer_load_dwordx4 v[8:11], v47, s[52:55], s90 offen sc1
    s_waitcnt vmcnt(2)
    v_max_u32 v38, v8, v12
    v_cmp_eq_u32 vcc, -1, v38
    v_mov_b64 v[36:37], v[12:13]
    v_mov_b64 v[32:33], v[8:9]
    v_mov_b64 v[34:35], v[10:11]
    s_cbranch_vccnz L_retry_114
L_got_113:
    v_add_f32_dpp v37, v37, v37 row_ror:4 row_mask:0xf bank_mask:0xf
    v_permlane32_swap_b32 v32, v34
    v_add_f32_dpp v36, v36, v36 row_ror:4 row_mask:0xf bank_mask:0xf
    v_permlane32_swap_b32 v33, v35
    v_add_f32_dpp v37, v37, v37 row_ror:2 row_mask:0xf bank_mask:0xf
    v_pk_add_f32 v[32:33], v[32:33], v[34:35]
    v_add_f32_dpp v36, v36, v36 row_ror:2 row_mask:0xf bank_mask:0xf
    s_nop 0
    v_permlane16_swap_b32 v32, v33
    v_add_f32_dpp v37, v37, v37 row_ror:1 row_mask:0xf bank_mask:0xf
    v_add_f32 v32, v32, v33
    v_add_f32_dpp v36, v36, v36 row_ror:1 row_mask:0xf bank_mask:0xf
    s_nop 0
    v_add_f32_dpp v32, v32, v32 row_ror:8 row_mask:0xf bank_mask:0xf
    v_mul_f32 v37, 0x37e38e39, v37
    v_and_b32 v33, 0xffff0000, v1
    v_mul_f32 v36, 0x37e38e39, v36
    v_fma_f32 v36, -v37, v37, v36
    v_max_f32 v36, 0, v36
    v_fmaak_f32 v36, v39, v36, 0x3a21369a
    v_rsq_f32 v36, v36
    v_fma_f32 v32, -v37, v33, v32
    v_mul_f32 v32, v32, v36
    v_cvt_pk_bf16_f32 v32, v32, v32
    ds_write_b16 v44, v32
    v_lshlrev_b32 v33, 16, v32
    v_cmp_u_f32 vcc, v33, v33
    s_sub_u32 s80, s68, 148480
    s_cmp_eq_u32 s66, 0
    s_cselect_b32 s81, s18, 1073741824
    s_mov_b32 s22, 196611
    s_mov_b32 s23, 196611
    s_cbranch_vccnz L_retry_116
L_got_115:
    s_waitcnt vmcnt(0) lgkmcnt(0)
    s_barrier
    ds_read_b128 v[32:35], v56 offset:0
    ds_read_b128 v[36:39], v56 offset:128
    ds_read_b128 v[40:43], v57 offset:0
    ds_read_b128 v[44:47], v57 offset:128
    ds_read_b128 v[48:51], v58 offset:0
    ds_read_b128 v[52:55], v58 offset:128
    v_mov_b32 v14, v2
    s_waitcnt lgkmcnt(5)
    v_smfmac_f32_16x16x64_bf16 v[16:19], v[32:35], a[0:7], v1
    s_add_u32 m0, s68, 0
    s_waitcnt lgkmcnt(4)
    v_smfmac_f32_16x16x64_bf16 v[16:19], v[36:39], a[8:15], v1
    ds_read_b64_tr_b16 a[0:1], v14 offset:0
    buffer_load_dwordx4 v61, s[28:31], s93 offen offset:0 lds
    v_smfmac_f32_16x16x64_bf16 v[20:23], v[32:35], a[16:23], v1
    ds_read_b64_tr_b16 a[2:3], v14 offset:4096
    v_smfmac_f32_16x16x64_bf16 v[20:23], v[36:39], a[24:31], v1
    ds_read_b64_tr_b16 a[4:5], v14 offset:8192
    v_smfmac_f32_16x16x64_bf16 v[24:27], v[32:35], a[32:39], v1
    ds_read_b64_tr_b16 a[6:7], v14 offset:12288
    v_xor_b32 v15, 32, v2
    v_smfmac_f32_16x16x64_bf16 v[24:27], v[36:39], a[40:47], v1
    ds_read_b64_tr_b16 a[8:9], v15 offset:0
    v_mov_b64 v[8:9], 0
    v_smfmac_f32_16x16x64_bf16 v[28:31], v[32:35], a[48:55], v1
    ds_read_b64_tr_b16 a[10:11], v15 offset:4096
    v_mov_b64 v[12:13], 0
    s_add_u32 m0, s68, 0
    v_smfmac_f32_16x16x64_bf16 v[28:31], v[36:39], a[56:63], v1
    ds_read_b64_tr_b16 a[12:13], v15 offset:8192
    buffer_load_dwordx4 v62, s[28:31], s93 offen offset:1024 lds
    s_waitcnt lgkmcnt(7)
    v_smfmac_f32_16x16x64_bf16 v[16:19], v[40:43], a[64:71], v1
    ds_read_b128 v[32:35], v59 offset:0
    v_mov_b32 v10, s80
    v_smfmac_f32_16x16x64_bf16 v[16:19], v[44:47], a[72:79], v1
    ds_read_b128 v[36:39], v59 offset:128
    v_smfmac_f32_16x16x64_bf16 v[20:23], v[40:43], a[80:87], v1
    ds_read_b64_tr_b16 a[14:15], v15 offset:12288
    v_xor_b32 v14, 64, v2
    v_smfmac_f32_16x16x64_bf16 v[20:23], v[44:47], a[88:95], v1
    ds_read_b64_tr_b16 a[16:17], v14 offset:0
    v_smfmac_f32_16x16x64_bf16 v[24:27], v[40:43], a[96:103], v1
    ds_read_b64_tr_b16 a[18:19], v14 offset:4096
    s_add_u32 m0, s68, 0
    v_smfmac_f32_16x16x64_bf16 v[24:27], v[44:47], a[104:111], v1
    ds_read_b64_tr_b16 a[20:21], v14 offset:8192
    buffer_load_dwordx4 v63, s[28:31], s93 offen offset:2048 lds
    v_smfmac_f32_16x16x64_bf16 v[28:31], v[40:43], a[112:119], v1
    ds_read_b64_tr_b16 a[22:23], v14 offset:12288
    v_xor_b32 v15, 96, v2
    v_smfmac_f32_16x16x64_bf16 v[28:31], v[44:47], a[120:127], v1
    ds_read_b64_tr_b16 a[24:25], v15 offset:0
    v_smfmac_f32_16x16x64_bf16 v[16:19], v[48:51], a[128:135], v1
    ds_read_b64_tr_b16 a[26:27], v15 offset:4096
    v_smfmac_f32_16x16x64_bf16 v[16:19], v[52:55], a[136:143], v1
    ds_read_b64_tr_b16 a[28:29], v15 offset:8192
    v_smfmac_f32_16x16x64_bf16 v[20:23], v[48:51], a[144:151], v1
    ds_read_b64_tr_b16 a[30:31], v15 offset:12288
    s_add_u32 m0, s68, 3072
    v_xor_b32 v14, 128, v2
    v_smfmac_f32_16x16x64_bf16 v[20:23], v[52:55], a[152:159], v1
    ds_read_b64_tr_b16 a[32:33], v14 offset:0
    buffer_load_dwordx4 v61, s[28:31], s83 offen offset:0 lds
    v_smfmac_f32_16x16x64_bf16 v[24:27], v[48:51], a[160:167], v1
    ds_read_b64_tr_b16 a[34:35], v14 offset:4096
    v_smfmac_f32_16x16x64_bf16 v[24:27], v[52:55], a[168:175], v1
    ds_read_b64_tr_b16 a[36:37], v14 offset:8192
    v_smfmac_f32_16x16x64_bf16 v[28:31], v[48:51], a[176:183], v1
    ds_read_b64_tr_b16 a[38:39], v14 offset:12288
    v_xor_b32 v15, 160, v2
    v_smfmac_f32_16x16x64_bf16 v[28:31], v[52:55], a[184:191], v1
    ds_read_b64_tr_b16 a[40:41], v15 offset:0
    s_waitcnt lgkmcnt(14)
    v_smfmac_f32_16x16x64_bf16 v[16:19], v[32:35], a[192:199], v1
    ds_read_b64_tr_b16 a[42:43], v15 offset:4096
    s_add_u32 m0, s68, 3072
    v_smfmac_f32_16x16x64_bf16 v[16:19], v[36:39], a[200:207], v1
    ds_read_b64_tr_b16 a[44:45], v15 offset:8192
    buffer_load_dwordx4 v62, s[28:31], s83 offen offset:1024 lds
    v_smfmac_f32_16x16x64_bf16 v[20:23], v[32:35], a[208:215], v1
    ds_read_b64_tr_b16 a[46:47], v15 offset:12288
    v_xor_b32 v14, 192, v2
    v_smfmac_f32_16x16x64_bf16 v[20:23], v[36:39], a[216:223], v1
    ds_read_b64_tr_b16 a[48:49], v14 offset:0
    v_smfmac_f32_16x16x64_bf16 v[24:27], v[32:35], a[224:231], v1
    ds_read_b64_tr_b16 a[50:51], v14 offset:4096
    v_smfmac_f32_16x16x64_bf16 v[24:27], v[36:39], a[232:239], v1
    ds_read_b64_tr_b16 a[52:53], v14 offset:8192
    v_smfmac_f32_16x16x64_bf16 v[28:31], v[32:35], a[240:247], v1
    ds_read_b64_tr_b16 a[54:55], v14 offset:12288
    s_add_u32 m0, s68, 3072
    v_xor_b32 v15, 224, v2
    v_smfmac_f32_16x16x64_bf16 v[28:31], v[36:39], a[248:255], v1
    ds_read_b64_tr_b16 a[56:57], v15 offset:0
    buffer_load_dwordx4 v63, s[28:31], s83 offen offset:2048 lds
    ds_read_b64_tr_b16 a[58:59], v15 offset:4096
    v_add_f32 v16, v16, v17
    ds_read_b64_tr_b16 a[60:61], v15 offset:8192
    v_add_f32 v17, v20, v21
    ds_read_b64_tr_b16 a[62:63], v15 offset:12288
    v_add_f32 v18, v24, v25
    v_add_f32 v19, v28, v29
    v_max3_f32 v20, v16, v17, v18
    v_max_f32 v20, v20, v19
    v_cndmask_b32 v11, 0, v10, s[22:23]
    v_add_u32 v56, v56, v11
    v_max_f32_dpp v20, v20, v20 row_ror:8 row_mask:0xf bank_mask:0xf
    s_lshl_b64 s[22:23], s[22:23], 4
    v_cndmask_b32 v11, 0, v10, s[22:23]
    v_max_f32_dpp v20, v20, v20 row_ror:4 row_mask:0xf bank_mask:0xf
    v_add_u32 v57, v57, v11
    s_lshl_b64 s[22:23], s[22:23], 4
    v_max_f32_dpp v20, v20, v20 row_ror:2 row_mask:0xf bank_mask:0xf
    v_cndmask_b32 v11, 0, v10, s[22:23]
    v_add_u32 v58, v58, v11
    v_max_f32_dpp v20, v20, v20 row_ror:1 row_mask:0xf bank_mask:0xf
    s_lshl_b64 s[22:23], s[22:23], 4
    v_cndmask_b32 v11, 0, v10, s[22:23]
    v_max_f32_dpp v20, v20, v20 row_bcast:15 row_mask:0xa bank_mask:0xf
    v_add_u32 v59, v59, v11
    s_nop 0
    v_max_f32_dpp v20, v20, v20 row_bcast:31 row_mask:0xc bank_mask:0xf
    s_nop 0
    v_readlane_b32 s73, v20, 63
    s_nop 1
    v_subrev_f32 v16, s73, v16
    v_subrev_f32 v17, s73, v17
    v_subrev_f32 v18, s73, v18
    v_subrev_f32 v19, s73, v19
    v_exp_f32 v16, v16
    v_exp_f32 v17, v17
    v_exp_f32 v18, v18
    v_exp_f32 v19, v19
    v_cvt_pk_bf16_f32 v22, v16, v17
    v_cvt_pk_bf16_f32 v23, v18, v19
    ds_write_b16 v60, v22 offset:6144
    ds_write_b16_d16_hi v60, v22 offset:6148
    ds_write_b16 v60, v23 offset:6208
    ds_write_b16_d16_hi v60, v23 offset:6212
    ds_read_b128 v[32:35], v56 offset:0
    ds_read_b128 v[36:39], v56 offset:128
    ds_read_b128 v[40:43], v56 offset:256
    ds_read_b128 v[44:47], v56 offset:384
    v_pk_add_f32 v[16:17], v[16:17], v[18:19]
    v_add_f32 v21, v16, v17
    s_lshl_b32 s78, s66, 3
    s_add_u32 s78, s78, 138240
    v_add_f32_dpp v21, v21, v21 row_ror:8 row_mask:0xf bank_mask:0xf
    v_mov_b32 v22, 0x30000
    v_mov_b32 v20, s73
    v_add_f32_dpp v21, v21, v21 row_ror:4 row_mask:0xf bank_mask:0xf
    s_mov_b32 s23, 138240
    s_waitcnt lgkmcnt(3)
    v_smfmac_f32_16x16x64_bf16 v[8:11], v[32:35], v[64:71], v1
    v_add_f32_dpp v21, v21, v21 row_ror:2 row_mask:0xf bank_mask:0xf
    v_smfmac_f32_16x16x64_bf16 v[12:15], v[32:35], v[96:103], v1
    ds_read_b128 v[48:51], v57 offset:0
    v_add_f32_dpp v21, v21, v21 row_ror:1 row_mask:0xf bank_mask:0xf
    s_waitcnt lgkmcnt(3)
    v_smfmac_f32_16x16x64_bf16 v[8:11], v[36:39], v[128:135], v1
    v_add_f32_dpp v21, v21, v21 row_bcast:15 row_mask:0xa bank_mask:0xf
    v_smfmac_f32_16x16x64_bf16 v[12:15], v[36:39], v[160:167], v1
    ds_read_b128 v[52:55], v57 offset:128
    v_add_f32_dpp v21, v21, v21 row_bcast:31 row_mask:0xc bank_mask:0xf
    s_waitcnt lgkmcnt(2)
    v_smfmac_f32_16x16x64_bf16 v[8:11], v[40:43], v[192:199], v1
    v_writelane_b32 v22, s78, 63
    ds_write_b64 v22, v[20:21]
    v_smfmac_f32_16x16x64_bf16 v[12:15], v[40:43], v[224:231], v1
    ds_read_b128 v[32:35], v57 offset:256
    v_smfmac_f32_16x16x64_bf16 v[8:11], v[44:47], a[0:7], v1
    v_and_b32 v23, 3, v0
    v_smfmac_f32_16x16x64_bf16 v[12:15], v[44:47], a[32:39], v1
    ds_read_b128 v[36:39], v57 offset:384
    s_waitcnt lgkmcnt(3)
    v_smfmac_f32_16x16x64_bf16 v[8:11], v[48:51], v[72:79], v1
    s_waitcnt lgkmcnt(2)
    s_barrier
    v_smfmac_f32_16x16x64_bf16 v[12:15], v[48:51], v[104:111], v1
    ds_read_b128 v[40:43], v58 offset:0
    v_lshl_add_u32 v23, v23, 3, s23
    ds_read_b64 v[24:25], v23
    v_smfmac_f32_16x16x64_bf16 v[8:11], v[52:55], v[136:143], v1
    v_smfmac_f32_16x16x64_bf16 v[12:15], v[52:55], v[168:175], v1
    ds_read_b128 v[44:47], v58 offset:128
    s_waitcnt lgkmcnt(3)
    v_smfmac_f32_16x16x64_bf16 v[8:11], v[32:35], v[200:207], v1
    v_smfmac_f32_16x16x64_bf16 v[12:15], v[32:35], v[232:239], v1
    ds_read_b128 v[48:51], v58 offset:256
    s_waitcnt lgkmcnt(2)
    v_smfmac_f32_16x16x64_bf16 v[8:11], v[36:39], a[8:15], v1
    v_max_f32_dpp v22, v24, v24 quad_perm:[1,0,3,2] row_mask:0xf bank_mask:0xf
    v_smfmac_f32_16x16x64_bf16 v[12:15], v[36:39], a[40:47], v1
    ds_read_b128 v[52:55], v58 offset:384
    v_max_f32_dpp v22, v22, v22 quad_perm:[2,3,0,1] row_mask:0xf bank_mask:0xf
    s_waitcnt lgkmcnt(2)
    v_smfmac_f32_16x16x64_bf16 v[8:11], v[40:43], v[80:87], v1
    v_sub_f32 v24, v24, v22
    v_smfmac_f32_16x16x64_bf16 v[12:15], v[40:43], v[112:119], v1
    ds_read_b128 v[32:35], v59 offset:0
    v_exp_f32 v24, v24
    v_smfmac_f32_16x16x64_bf16 v[8:11], v[44:47], v[144:151], v1
    v_mul_f32 v19, v24, v25
    v_smfmac_f32_16x16x64_bf16 v[12:15], v[44:47], v[176:183], v1
    ds_read_b128 v[36:39], v59 offset:128
    s_waitcnt lgkmcnt(2)
    v_smfmac_f32_16x16x64_bf16 v[8:11], v[48:51], v[208:215], v1
    v_add_f32_dpp v19, v19, v19 quad_perm:[1,0,3,2] row_mask:0xf bank_mask:0xf
    v_smfmac_f32_16x16x64_bf16 v[12:15], v[48:51], v[240:247], v1
    ds_read_b128 v[40:43], v59 offset:256
    v_smfmac_f32_16x16x64_bf16 v[8:11], v[52:55], a[16:23], v1
    v_add_f32_dpp v19, v19, v19 quad_perm:[2,3,0,1] row_mask:0xf bank_mask:0xf
    v_smfmac_f32_16x16x64_bf16 v[12:15], v[52:55], a[48:55], v1
    ds_read_b128 v[44:47], v59 offset:384
    v_log_f32 v25, v19
    s_waitcnt lgkmcnt(2)
    v_smfmac_f32_16x16x64_bf16 v[8:11], v[32:35], v[88:95], v1
    v_add_f32 v25, v25, v22
    v_smfmac_f32_16x16x64_bf16 v[12:15], v[32:35], v[120:127], v1
    buffer_store_dword v25, off, s[52:55], s81
    v_smfmac_f32_16x16x64_bf16 v[8:11], v[36:39], v[152:159], v1
    v_sub_f32 v18, s73, v25
    v_smfmac_f32_16x16x64_bf16 v[12:15], v[36:39], v[184:191], v1
    v_exp_f32 v18, v18
    s_waitcnt lgkmcnt(0)
    v_smfmac_f32_16x16x64_bf16 v[8:11], v[40:43], v[216:223], v1
    v_lshrrev_b32 v23, 4, v0
    v_smfmac_f32_16x16x64_bf16 v[12:15], v[40:43], v[248:255], v1
    v_lshl_add_u32 v23, v23, 1, v0
    v_smfmac_f32_16x16x64_bf16 v[8:11], v[44:47], a[24:31], v1
    v_and_b32 v23, 7, v23
    v_smfmac_f32_16x16x64_bf16 v[12:15], v[44:47], a[56:63], v1
    v_lshl_add_u32 v46, v0, 2, s68
    v_lshlrev_b32 v47, 2, v23
    s_nop 3
    v_add_f32 v44, v8, v9
    s_nop 0
    v_add_f32 v45, v12, v13
    v_pk_mul_f32 v[44:45], v[44:45], v[18:19] op_sel_hi:[1,0]
    s_branch L_top_fast
L_final_fast:
    s_cmp_lg_u32 s74, 3
    s_cbranch_scc1 L_fin2
    s_cmp_eq_u32 s74, 3
    s_cselect_b64 vcc, -1, 0
    v_lshlrev_b32 v36, 16, v34
    v_and_b32 v37, 0xffff0000, v34
    v_pk_add_f32 v[32:33], v[32:33], v[36:37] neg_lo:[0,1] neg_hi:[0,1]
    v_cndmask_b32 v4, 0, v32, vcc
    v_cndmask_b32 v5, 0, v33, vcc
    v_lshrrev_b32 v8, 4, v0
    v_mul_u32_u24 v8, 768, v8
    v_and_or_b32 v8, v0, 15, v8
    v_lshlrev_b32 v8, 2, v8
    s_mov_b32 vcc_lo, 4026593280
    s_mov_b32 vcc_hi, 4026593280
    v_cndmask_b32 v8, v8, 2.0, vcc
    s_mov_b64 vcc, 0xfff
    v_cndmask_b32 v4, 0, v4, vcc
    v_cndmask_b32 v5, 0, v5, vcc
    v_and_b32 v9, 15, v0
    v_lshrrev_b32 v10, 5, v0
    v_lshl_or_b32 v9, v9, 1, v10
    v_lshlrev_b32 v9, 1, v9
    s_mov_b32 vcc_lo, 4294963200
    s_mov_b32 vcc_hi, 4294963200
    v_cndmask_b32 v9, v9, 2.0, vcc
    v_mov_b32 v12, 0x3f80
    v_mov_b32 v13, 0x3f800000
    s_add_u32 s80, s20, 24576
    s_add_u32 s81, s80, 12288
    s_mul_i32 s78, s65, 48
    s_sleep 6
    buffer_load_dword v10, v8, s[56:59], s80 offen sc1
    buffer_load_dword v11, v8, s[56:59], s81 offen sc1
    v_mov_b64 v[14:15], v[4:5]
    s_waitcnt vmcnt(0)
L_chk_117:
    v_cmp_u_f32 vcc, v10, v11
    v_dot2c_f32_bf16 v14, v12, v10
    v_dot2c_f32_bf16 v15, v13, v10
    v_dot2c_f32_bf16 v14, v12, v11
    v_dot2c_f32_bf16 v15, v13, v11
    s_cbranch_vccnz L_retry_119
L_got_118:
    s_nop 1
    v_permlane32_swap_b32 v14, v15
    v_add_f32 v16, v14, v15
    v_add_f32 v14, v14, v15
    s_nop 1
    v_permlane16_swap_b32 v14, v16
    v_add_f32 v14, v14, v16
    v_cvt_pk_bf16_f32 v14, v14, v14
    buffer_store_short v14, v9, s[60:63], s78 offen
L_fin2:
L_end:
    s_endpgm
L_isl_0:
    s_branch L_isl_1
L_cretry_3:
    s_add_u32 s72, s72, 1
    s_cmp_gt_u32 s72, 200000
    s_cbranch_scc1 L_cdone_4
    s_sleep 8
    buffer_load_dwordx2 v[58:59], v57, s[16:19], 0 offen sc1
    s_waitcnt vmcnt(0)
    s_branch L_chk_2
L_isl_1:
    s_branch L_isl_2
L_retry_8:
    s_add_u32 s72, s72, 1
    s_cmp_gt_u32 s72, 200000
    s_cbranch_scc1 L_done_9
    buffer_load_dwordx2 v[52:53], v49, s[52:55], s91 offen sc1
    buffer_load_dwordx4 v[40:43], v51, s[52:55], s90 offen sc1
    buffer_load_dwordx4 v[44:47], v51, s[52:55], s82 offen sc1
    s_waitcnt vmcnt(0)
    s_branch L_chk_7
L_isl_2:
    s_branch L_isl_3
L_res_13:
    s_nop 1
    v_lshlrev_b32 v8, 2, v0
    s_add_u32 s80, s20, 24576
    s_mov_b64 exec, 0xfff
L_poll_5015:
    s_add_u32 s81, s80, 0
    buffer_load_dword v20, v8, s[56:59], s81 offen offset:0 sc1
    buffer_load_dword v21, v8, s[56:59], s81 offen offset:3072 sc1
    s_add_u32 s81, s80, 6144
    buffer_load_dword v22, v8, s[56:59], s81 offen offset:0 sc1
    buffer_load_dword v23, v8, s[56:59], s81 offen offset:3072 sc1
    s_add_u32 s81, s80, 12288
    buffer_load_dword v24, v8, s[56:59], s81 offen offset:0 sc1
    s_branch L_resp_15
L_isl_3:
    s_branch L_isl_4
L_resp_15:
    buffer_load_dword v25, v8, s[56:59], s81 offen offset:3072 sc1
    s_add_u32 s81, s80, 18432
    buffer_load_dword v26, v8, s[56:59], s81 offen offset:0 sc1
    buffer_load_dword v27, v8, s[56:59], s81 offen offset:3072 sc1
    v_mov_b32 v28, 0x3f80
    v_mov_b32 v29, 0x3f800000
    v_mov_b64 v[30:31], v[4:5]
    s_waitcnt vmcnt(6)
    v_dot2c_f32_bf16 v30, v28, v20
    v_dot2c_f32_bf16 v31, v29, v20
    v_dot2c_f32_bf16 v30, v28, v21
    v_dot2c_f32_bf16 v31, v29, v21
    s_waitcnt vmcnt(4)
    v_dot2c_f32_bf16 v30, v28, v22
    s_branch L_resp_16
L_isl_4:
    s_branch L_isl_5
L_resp_16:
    v_dot2c_f32_bf16 v31, v29, v22
    v_dot2c_f32_bf16 v30, v28, v23
    v_dot2c_f32_bf16 v31, v29, v23
    s_waitcnt vmcnt(2)
    v_dot2c_f32_bf16 v30, v28, v24
    v_dot2c_f32_bf16 v31, v29, v24
    v_dot2c_f32_bf16 v30, v28, v25
    v_dot2c_f32_bf16 v31, v29, v25
    s_waitcnt vmcnt(0)
    v_dot2c_f32_bf16 v30, v28, v26
    v_dot2c_f32_bf16 v31, v29, v26
    v_dot2c_f32_bf16 v30, v28, v27
    v_dot2c_f32_bf16 v31, v29, v27
    s_nop 2
    s_branch L_resp_17
L_isl_5:
    s_branch L_isl_6
L_resp_17:
    v_cmp_u_f32 vcc, v30, v31
    s_cbranch_vccnz L_retry_5019
L_got_5018:
    v_mov_b64 v[4:5], v[30:31]
    s_mov_b64 exec, -1
    s_branch L_resback_14
L_isl_6:
    s_branch L_isl_7
L_retry_5019:
    s_cselect_b32 s3, 1, 0
    s_add_u32 s72, s72, 1
    s_cmp_gt_u32 s72, 200000
    s_cbranch_scc0 L_poll_5015
    s_cmp_eq_u32 s3, 1
    s_branch L_got_5018
L_isl_7:
    s_branch L_isl_8
L_retry_23:
    s_cmp_gt_u32 s72, 200000
    s_cbranch_scc1 L_got_22
    buffer_load_dword v16, v47, s[52:55], s19 offen sc1
    s_add_u32 s72, s72, 1
    s_waitcnt vmcnt(1)
    s_branch L_chk_20
L_isl_8:
    s_branch L_isl_9
L_retry_26:
    s_cselect_b32 s3, 1, 0
    s_add_u32 s72, s72, 1
    s_cmp_gt_u32 s72, 200000
    s_nop 1
    s_cbranch_scc0 L_poll_24
    s_cmp_eq_u32 s3, 1
    s_branch L_got_25
L_isl_9:
    s_branch L_isl_10
L_retry_28:
    s_cselect_b32 s3, 1, 0
    s_add_u32 s72, s72, 1
    s_cmp_gt_u32 s72, 200000
    s_nop 1
    s_cbranch_scc0 L_poll_24
    s_cmp_eq_u32 s3, 1
    s_branch L_got_27
L_isl_10:
    s_branch L_isl_11
L_go_30:
    s_nop 1
    v_mov_b32 v56, -1
    v_mov_b32 v57, -1
    v_mov_b32 v58, -1
    v_mov_b32 v59, -1
    s_mul_i32 s79, s64, 49152
    s_mul_i32 s78, s65, 1536
    s_add_u32 s79, s79, s78
    s_mul_i32 s78, s66, 384
    s_add_u32 s79, s79, s78
    s_add_u32 s79, s79, 1441792
    s_mov_b64 exec, 16777215
    buffer_store_dwordx4 v[56:59], v6, s[48:51], s79 offen sc1
    s_branch L_p_32
L_isl_11:
    s_branch L_isl_12
L_p_32:
    s_mov_b64 exec, -1
    s_sleep 10
    s_nop 1
    s_branch L_back_31
L_isl_12:
    s_branch L_isl_13
L_retry_37:
    s_cmp_gt_u32 s72, 200000
    s_cbranch_scc1 L_got_36
    s_mov_b32 m0, s83
    s_mov_b64 exec, 0x77777777
    buffer_load_dword v13, v12, s[56:59], s82 offen sc1
    buffer_load_dwordx4 v12, s[56:59], s82 offen sc1 lds
    s_mov_b64 exec, -1
    s_add_u32 s72, s72, 1
    s_waitcnt vmcnt(0)
    s_branch L_chk_34
L_isl_13:
    s_branch L_isl_14
L_retry_40:
    s_cselect_b32 s3, 1, 0
    s_add_u32 s72, s72, 1
    s_cmp_gt_u32 s72, 200000
    s_nop 1
    s_cbranch_scc0 L_again_38
    s_cmp_eq_u32 s3, 1
    s_branch L_got_39
L_isl_14:
    s_branch L_isl_15
L_again_38:
    s_barrier
    s_branch L_retry_37
L_isl_15:
    s_branch L_isl_16
L_go_18:
    s_nop 1
    v_lshrrev_b32 v9, 4, v0
    v_lshlrev_b32 v8, 5, v9
    v_xor_b32 v8, v8, v6
    v_and_b32 v8, 0xf0, v8
    v_lshl_or_b32 v8, v9, 13, v8
    s_mov_b32 m0, s68
    s_add_u32 s79, s94, 0
    buffer_load_dwordx4 v8, s[36:39], s79 offen offset:0  lds
    s_add_u32 s79, s94, 31744
    v_xor_b32 v9, 128, v8
    buffer_load_dwordx4 v9, s[36:39], s79 offen offset:1024  lds
    s_add_u32 s79, s94, 63488
    s_branch L_p_41
L_isl_16:
    s_branch L_isl_17
L_p_41:
    v_xor_b32 v9, 144, v8
    buffer_load_dwordx4 v9, s[36:39], s79 offen offset:2048  lds
    s_add_u32 s79, s94, 95232
    v_xor_b32 v9, 16, v8
    buffer_load_dwordx4 v9, s[36:39], s79 offen offset:3072  lds
    v_lshlrev_b32 v60, 7, v0
    s_lshl_b32 s79, s64, 17
    s_lshl_b32 s78, s65, 12
    s_add_u32 s79, s79, s78
    s_lshl_b32 s78, s66, 10
    s_add_u32 s79, s79, s78
    s_mov_b32 exec_lo, 255
    s_mov_b32 exec_hi, 0
    buffer_load_dword v10, v60, s[48:51], s79 offen
    s_branch L_p_42
L_isl_17:
    s_branch L_isl_18
L_p_42:
    s_mov_b64 exec, -1
    s_lshl_b32 s79, s65, 10
    s_lshl_b32 s78, s66, 8
    s_add_u32 s79, s79, s78
    v_lshl_add_u32 v60, v0, 7, s79
    v_min_u32 v60, L_tailend-L_top_fast, v60
    s_getpc_b64 s[78:79]
L_pc_18041:
    s_add_u32 s78, s78, L_top_fast-L_pc_18041
    s_addc_u32 s79, s79, -1
    s_mov_b64 exec, 3
    global_load_dword v10, v60, s[78:79]
    s_mov_b64 exec, -1
    s_cmp_eq_u32 s71, 1
    s_branch L_p_43
L_isl_18:
    s_branch L_isl_19
L_p_43:
    s_cbranch_scc1 L_it1_18042
    v_mov_b32 v56, -1
    v_mov_b32 v57, -1
    v_mov_b32 v58, -1
    v_mov_b32 v59, -1
    s_mul_i32 s79, s64, 49152
    s_mul_i32 s78, s65, 1536
    s_add_u32 s79, s79, s78
    s_mul_i32 s78, s66, 384
    s_add_u32 s79, s79, s78
    s_add_u32 s79, s79, 1441792
    s_mov_b64 exec, 16777215
    buffer_store_dwordx4 v[56:59], v6, s[48:51], s79 offen sc1
    s_mov_b64 exec, -1
    s_branch L_p_44
L_isl_19:
    s_branch L_isl_20
L_p_44:
    v_lshrrev_b32 v60, 3, v0
    v_lshlrev_b32 v60, 6, v60
    v_and_or_b32 v60, v0, 7, v60
    v_lshlrev_b32 v60, 7, v60
    s_lshl_b32 s79, s64, 10
    s_mul_i32 s78, s65, 393216
    s_add_u32 s79, s79, s78
    s_mul_i32 s78, s66, 98304
    s_add_u32 s79, s79, s78
    s_add_u32 s79, s79, 4285530112
    buffer_load_dword v10, v60, s[36:39], s79 offen
    s_add_u32 s79, s79, 65536
    s_mov_b32 exec_lo, 4294967295
    s_mov_b32 exec_hi, 0
    s_branch L_p_45
L_isl_20:
    s_branch L_isl_21
L_p_45:
    buffer_load_dword v10, v60, s[36:39], s79 offen
    s_add_u32 s79, s79, 65536
    s_mov_b64 exec, -1
    v_lshlrev_b32 v60, 7, v0
    s_mul_i32 s79, s64, 589824
    s_mul_i32 s78, s65, 73728
    s_add_u32 s79, s79, s78
    s_mul_i32 s78, s66, 18432
    s_add_u32 s79, s79, s78
    s_add_u32 s79, s79, 4293197824
    buffer_load_dword v10, v60, s[44:47], s79 offen
    s_add_u32 s79, s79, 8192
    buffer_load_dword v10, v60, s[44:47], s79 offen
    s_add_u32 s79, s79, 8192
    s_branch L_p_46
L_isl_21:
    s_branch L_isl_22
L_p_46:
    s_mov_b32 exec_lo, 65535
    s_mov_b32 exec_hi, 0
    buffer_load_dword v10, v60, s[44:47], s79 offen
    s_add_u32 s79, s79, 8192
    s_mov_b64 exec, -1
    s_branch L_it1_18043
L_it1_18042:
    s_sleep 30
L_it1_18043:
    s_waitcnt vmcnt(0)
    s_nop 1
    s_branch L_back_19
L_isl_22:
    s_branch L_isl_23
L_cs_48:
    buffer_load_dwordx4 v[16:19], v33, s[52:55], s4 offen offset:2048 sc1
    buffer_load_dwordx4 v[20:23], v33, s[52:55], s4 offen offset:3072 sc1
    s_branch L_csb_49
L_isl_23:
    s_branch L_isl_24
L_retry_51:
    s_cselect_b32 s3, 1, 0
    s_add_u32 s72, s72, 1
    s_cmp_gt_u32 s72, 200000
    s_nop 1
    s_cbranch_scc0 L_poll_47
    s_cmp_eq_u32 s3, 1
    s_branch L_got_50
L_isl_24:
    s_branch L_isl_25
L_retry_53:
    s_cselect_b32 s3, 1, 0
    s_add_u32 s72, s72, 1
    s_cmp_gt_u32 s72, 200000
    s_nop 1
    s_cbranch_scc0 L_poll_47
    s_cmp_eq_u32 s3, 1
    s_branch L_got_52
L_isl_25:
    s_branch L_isl_26
L_res_55:
    s_nop 1
    v_lshlrev_b32 v8, 2, v0
    s_add_u32 s80, s20, 0
    s_mov_b64 exec, 0xfff
L_poll_28057:
    s_add_u32 s81, s80, 0
    buffer_load_dword v10, v8, s[56:59], s81 offen offset:0 sc1
    buffer_load_dword v11, v8, s[56:59], s81 offen offset:3072 sc1
    s_add_u32 s81, s80, 6144
    buffer_load_dword v12, v8, s[56:59], s81 offen offset:0 sc1
    buffer_load_dword v13, v8, s[56:59], s81 offen offset:3072 sc1
    s_add_u32 s81, s80, 12288
    buffer_load_dword v14, v8, s[56:59], s81 offen offset:0 sc1
    s_branch L_resp_57
L_isl_26:
    s_branch L_isl_27
L_resp_57:
    buffer_load_dword v15, v8, s[56:59], s81 offen offset:3072 sc1
    s_add_u32 s81, s80, 18432
    buffer_load_dword v16, v8, s[56:59], s81 offen offset:0 sc1
    buffer_load_dword v17, v8, s[56:59], s81 offen offset:3072 sc1
    v_mov_b32 v18, 0x3f80
    v_mov_b32 v19, 0x3f800000
    v_mov_b64 v[20:21], v[4:5]
    s_waitcnt vmcnt(6)
    v_dot2c_f32_bf16 v20, v18, v10
    v_dot2c_f32_bf16 v21, v19, v10
    v_dot2c_f32_bf16 v20, v18, v11
    v_dot2c_f32_bf16 v21, v19, v11
    s_waitcnt vmcnt(4)
    v_dot2c_f32_bf16 v20, v18, v12
    s_branch L_resp_58
L_isl_27:
    s_branch L_isl_28
L_resp_58:
    v_dot2c_f32_bf16 v21, v19, v12
    v_dot2c_f32_bf16 v20, v18, v13
    v_dot2c_f32_bf16 v21, v19, v13
    s_waitcnt vmcnt(2)
    v_dot2c_f32_bf16 v20, v18, v14
    v_dot2c_f32_bf16 v21, v19, v14
    v_dot2c_f32_bf16 v20, v18, v15
    v_dot2c_f32_bf16 v21, v19, v15
    s_waitcnt vmcnt(0)
    v_dot2c_f32_bf16 v20, v18, v16
    v_dot2c_f32_bf16 v21, v19, v16
    v_dot2c_f32_bf16 v20, v18, v17
    v_dot2c_f32_bf16 v21, v19, v17
    s_nop 2
    s_branch L_resp_59
L_isl_28:
    s_branch L_isl_29
L_resp_59:
    v_cmp_u_f32 vcc, v20, v21
    s_cbranch_vccnz L_retry_28061
L_got_28060:
    v_mov_b64 v[4:5], v[20:21]
    s_mov_b64 exec, -1
    s_branch L_resback_56
L_isl_29:
    s_branch L_isl_30
L_retry_28061:
    s_cselect_b32 s3, 1, 0
    s_add_u32 s72, s72, 1
    s_cmp_gt_u32 s72, 200000
    s_cbranch_scc0 L_poll_28057
    s_cmp_eq_u32 s3, 1
    s_branch L_got_28060
L_isl_30:
    s_branch L_isl_31
L_go_60:
    s_nop 1
    s_mov_b64 s[80:81], s[0:1]
    s_mov_b32 s82, 0x10000
    s_mov_b32 s83, 0x20000
    v_lshrrev_b32 v19, 4, v0
    v_lshlrev_b32 v18, 5, v19
    v_xor_b32 v18, v18, v6
    v_and_b32 v18, 0xf0, v18
    v_lshl_or_b32 v18, v19, 10, v18
    v_xor_b32 v19, 0, v18
    s_not_b64 exec, s[84:85]
    s_add_u32 m0, s69, 73728
    s_mov_b32 s79, 32768
    s_branch L_p_62
L_isl_31:
    s_branch L_isl_32
L_p_62:
    buffer_load_dwordx4 v19, s[80:83], s79 offen nt lds
    s_add_u32 m0, s69, 77824
    s_mov_b32 s79, 49152
    buffer_load_dwordx4 v19, s[80:83], s79 offen nt lds
    s_mov_b64 exec, -1
    v_xor_b32 v19, 128, v18
    s_mov_b64 exec, s[84:85]
    s_add_u32 m0, s69, 74752
    s_mov_b32 s79, 36864
    buffer_load_dwordx4 v19, s[80:83], s79 offen nt lds
    s_add_u32 m0, s69, 78848
    s_mov_b32 s79, 53248
    buffer_load_dwordx4 v19, s[80:83], s79 offen nt lds
    s_mov_b64 exec, -1
    s_branch L_p_63
L_isl_32:
    s_branch L_isl_33
L_p_63:
    v_xor_b32 v19, 144, v18
    s_mov_b64 exec, s[84:85]
    s_add_u32 m0, s69, 75776
    s_mov_b32 s79, 40960
    buffer_load_dwordx4 v19, s[80:83], s79 offen nt lds
    s_add_u32 m0, s69, 79872
    s_mov_b32 s79, 57344
    buffer_load_dwordx4 v19, s[80:83], s79 offen nt lds
    s_mov_b64 exec, -1
    v_xor_b32 v19, 16, v18
    s_not_b64 exec, s[84:85]
    s_add_u32 m0, s69, 76800
    s_mov_b32 s79, 45056
    buffer_load_dwordx4 v19, s[80:83], s79 offen nt lds
    s_branch L_p_64
L_isl_33:
    s_branch L_isl_34
L_p_64:
    s_add_u32 m0, s69, 80896
    s_mov_b32 s79, 61440
    buffer_load_dwordx4 v19, s[80:83], s79 offen nt lds
    s_mov_b64 exec, -1
    v_mov_b32 v12, -1
    v_mov_b32 v13, -1
    v_mov_b32 v14, -1
    v_mov_b32 v15, -1
    v_lshrrev_b32 v16, 4, v0
    v_and_b32 v17, 0xf0, v6
    v_lshl_or_b32 v16, v16, 16, v17
    s_add_u32 s79, s8, 0
    buffer_store_dwordx4 v[12:15], v16, s[48:51], s79 offen
    s_add_u32 s79, s8, 4096
    s_branch L_p_65
L_isl_34:
    s_branch L_isl_35
L_p_65:
    buffer_store_dwordx4 v[12:15], v16, s[48:51], s79 offen
    s_add_u32 s79, s8, 8192
    buffer_store_dwordx4 v[12:15], v16, s[48:51], s79 offen
    s_add_u32 s79, s8, 12288
    buffer_store_dwordx4 v[12:15], v16, s[48:51], s79 offen
    s_sleep 2
    s_nop 1
    s_branch L_back_61
L_isl_35:
    s_branch L_isl_36
L_retry_70:
    s_cmp_gt_u32 s72, 200000
    s_cbranch_scc1 L_got_69
    s_mov_b32 m0, s68
    s_mov_b32 exec_lo, 4294967295
    s_mov_b32 exec_hi, 0
    buffer_load_dword v9, v8, s[56:59], s7 offen sc1
    s_mov_b64 exec, -1
    buffer_load_dwordx4 v58, s[56:59], s7 offen offset:0 sc1 lds
    buffer_load_dwordx4 v58, s[56:59], s7 offen offset:1024 sc1 lds
    buffer_load_dwordx4 v58, s[56:59], s7 offen offset:2048 sc1 lds
    buffer_load_dwordx4 v58, s[56:59], s7 offen offset:3072 sc1 lds
    s_add_u32 s72, s72, 1
    s_nop 0
    s_branch L_chk_67
L_isl_36:
    s_branch L_isl_37
L_retry_73:
    s_cselect_b32 s3, 1, 0
    s_add_u32 s72, s72, 1
    s_cmp_gt_u32 s72, 200000
    s_nop 1
    s_cbranch_scc0 L_again_71
    s_cmp_eq_u32 s3, 1
    s_branch L_got_72
L_isl_37:
    s_branch L_isl_38
L_again_71:
    s_waitcnt lgkmcnt(0)
    v_and_b32 v58, 12, v0
    v_lshlrev_b32 v58, 4, v58
    v_and_or_b32 v58, v0, 48, v58
    v_lshlrev_b32 v58, 2, v58
    v_and_or_b32 v58, v6, 48, v58
    v_lshlrev_b32 v8, 7, v0
    v_mov_b32 v9, 0
    s_barrier
    s_branch L_poll_66
L_isl_38:
    s_branch L_isl_39
L_retry_77:
    s_cmp_gt_u32 s72, 200000
    s_cbranch_scc1 L_got_76
    buffer_load_dwordx2 v[22:23], v60, s[52:55], s11 offen sc1
    s_add_u32 s72, s72, 1
    s_waitcnt vmcnt(1)
    s_branch L_chk_74
L_isl_39:
    s_branch L_isl_40
L_retry_81:
    s_cselect_b32 s3, 1, 0
    s_add_u32 s72, s72, 1
    s_cmp_gt_u32 s72, 200000
    s_nop 1
    s_cbranch_scc0 L_again_79
    s_cmp_eq_u32 s3, 1
    s_branch L_got_80
L_isl_40:
    s_branch L_isl_41
L_again_79:
    buffer_load_dwordx4 v[8:11], v6, s[48:51], s10 offen offset:0 sc1
    buffer_load_dwordx4 v[12:15], v6, s[48:51], s10 offen offset:1024 sc1
    buffer_load_dwordx4 v[16:19], v6, s[48:51], s10 offen offset:2048 sc1
    buffer_load_dwordx4 v[20:23], v6, s[48:51], s10 offen offset:3072 sc1
    v_mov_b64 v[28:29], 0
    v_mov_b64 v[30:31], 0
    v_mov_b64 v[32:33], 0
    v_mov_b64 v[34:35], 0
    s_waitcnt vmcnt(0)
    s_branch L_acc_78
L_isl_41:
    s_branch L_isl_42
L_go_82:
    s_nop 1
    v_mov_b32 v8, -1
    v_mov_b32 v9, -1
    v_mov_b32 v10, -1
    v_mov_b32 v11, -1
    s_mul_i32 s80, s65, 1792
    s_mul_i32 s78, s66, 448
    s_add_u32 s80, s80, s78
    s_add_u32 s80, s80, 73728
    s_mov_b64 exec, 0xfffffff
    buffer_store_dwordx4 v[8:11], v6, s[52:55], s80 offen
    s_mov_b64 exec, -1
    s_nop 1
    s_branch L_p_84
L_isl_42:
    s_branch L_isl_43
L_p_84:
    s_branch L_back_83
L_isl_43:
    s_branch L_isl_44
L_retry_89:
    s_cmp_gt_u32 s72, 200000
    s_cbranch_scc1 L_got_88
    buffer_load_dword v16, v29, s[56:59], s15 offen sc1
    s_add_u32 s72, s72, 1
    s_waitcnt vmcnt(0)
    s_branch L_chk_86
L_isl_44:
    s_branch L_isl_45
L_retry_91:
    s_cmp_gt_u32 s72, 200000
    s_cbranch_scc1 L_got_90
    buffer_load_dwordx4 v[8:11], v28, s[56:59], s14 offen sc1
    s_nop 7
    v_mov_b64 v[20:21], 0
    v_mov_b64 v[22:23], 0
    v_mov_b64 v[24:25], 0
    v_mov_b64 v[26:27], 0
    s_add_u32 s72, s72, 1
    s_waitcnt vmcnt(0)
    s_branch L_chk_87
L_isl_45:
    s_branch L_isl_46
L_retry_93:
    s_cmp_gt_u32 s72, 200000
    s_cbranch_scc1 L_got_92
    buffer_load_dwordx4 v[8:11], v28, s[56:59], s14 offen sc1
    v_mov_b64 v[20:21], 0
    v_mov_b64 v[22:23], 0
    v_mov_b64 v[24:25], 0
    v_mov_b64 v[26:27], 0
    s_add_u32 s72, s72, 1
    s_waitcnt vmcnt(0)
    s_branch L_chk_87
L_isl_46:
    s_branch L_isl_47
L_retry_98:
    s_cselect_b32 s3, 1, 0
    s_add_u32 s72, s72, 1
    s_cmp_gt_u32 s72, 200000
    s_nop 1
    s_cbranch_scc0 L_poll_96
    s_cmp_eq_u32 s3, 1
    s_branch L_got_97
L_isl_47:
    s_branch L_isl_48
L_retry_100:
    s_cselect_b32 s3, 1, 0
    s_add_u32 s72, s72, 1
    s_cmp_gt_u32 s72, 200000
    s_nop 1
    s_cbranch_scc0 L_poll_96
    s_cmp_eq_u32 s3, 1
    s_branch L_got_99
L_isl_48:
    s_branch L_isl_49
L_retry_105:
    s_cmp_gt_u32 s72, 200000
    s_cbranch_scc1 L_got_104
    s_mov_b32 m0, s83
    s_mov_b64 exec, 0x77777777
    buffer_load_dword v13, v12, s[56:59], s82 offen sc1
    buffer_load_dwordx4 v12, s[56:59], s82 offen sc1 lds
    s_mov_b64 exec, -1
    s_add_u32 s72, s72, 1
    s_waitcnt vmcnt(0)
    s_branch L_chk_102
L_isl_49:
    s_branch L_isl_50
L_retry_108:
    s_cselect_b32 s3, 1, 0
    s_add_u32 s72, s72, 1
    s_cmp_gt_u32 s72, 200000
    s_nop 1
    s_cbranch_scc0 L_again_106
    s_cmp_eq_u32 s3, 1
    s_branch L_got_107
L_isl_50:
    s_branch L_isl_51
L_again_106:
    s_barrier
    s_branch L_retry_105
L_isl_51:
    s_branch L_isl_52
L_go_94:
    s_nop 1
    s_cmp_eq_u32 s71, 1
    s_cbranch_scc1 L_final_fast
    s_add_u32 s52, s52, 73728
    s_addc_u32 s53, s53, 0
    s_mov_b32 s54, 57344
    s_mov_b32 s71, 1
    v_lshlrev_b32 v60, 7, v0
    s_lshl_b32 s79, s64, 17
    s_lshl_b32 s78, s65, 12
    s_add_u32 s79, s79, s78
    s_lshl_b32 s78, s66, 10
    s_add_u32 s79, s79, s78
    s_branch L_p_109
L_isl_52:
    s_branch L_isl_53
L_p_109:
    s_mov_b32 exec_lo, 255
    s_mov_b32 exec_hi, 0
    buffer_load_dword v10, v60, s[48:51], s79 offen
    s_mov_b64 exec, -1
    s_sleep 30
    s_waitcnt vmcnt(0)
    s_barrier
    s_nop 1
    s_branch L_back_95
L_isl_53:
    s_branch L_isl_54
L_retry_114:
    s_cselect_b32 s3, 1, 0
    s_add_u32 s72, s72, 1
    s_cmp_gt_u32 s72, 200000
    s_cbranch_scc0 L_poll_110
    s_cmp_eq_u32 s3, 1
    s_branch L_got_113
L_isl_54:
    s_branch L_isl_55
L_retry_116:
    s_cselect_b32 s3, 1, 0
    s_add_u32 s72, s72, 1
    s_cmp_gt_u32 s72, 200000
    s_nop 1
    s_cbranch_scc0 L_poll_110
    s_cmp_eq_u32 s3, 1
    s_branch L_got_115
L_isl_55:
    s_branch L_isl_56
L_retry_119:
    s_cmp_gt_u32 s72, 200000
    s_cbranch_scc1 L_got_118
    buffer_load_dword v10, v8, s[56:59], s80 offen sc1
    buffer_load_dword v11, v8, s[56:59], s81 offen sc1
    s_nop 1
    v_mov_b64 v[14:15], v[4:5]
    s_add_u32 s72, s72, 1
    s_waitcnt vmcnt(0)
    s_branch L_chk_117
L_slow_5:
    s_nop 7
    buffer_store_dword v52, v14, s[52:55], s87 offen sc1
    buffer_store_dword v60, v15, s[52:55], s89 offen offset:0 sc1
    s_branch L_back_6
L_slow_10:
    s_nop 7
    buffer_store_dword v62, off, s[52:55], s79 sc1
    s_branch L_back_11
L_isl_56:
    s_branch L_isl_ret
L_tailend:
L_codeend:
L_pre_slow:
    s_nop 7
    s_waitcnt vmcnt(0)
    ds_read_b64_tr_b16 v[56:57], v12 offset:12288
    ds_read_b64_tr_b16 v[58:59], v13 offset:12288
    ds_read_b64_tr_b16 v[60:61], v14 offset:12288
    ds_read_b64_tr_b16 v[62:63], v15 offset:12288
    ds_read_b64_tr_b16 v[20:21], v16 offset:12288
    ds_read_b64_tr_b16 v[22:23], v17 offset:12288
    ds_read_b64_tr_b16 v[8:9], v18 offset:12288
    ds_read_b64_tr_b16 v[12:13], v19 offset:12288
    v_lshrrev_b32 v14, 4, v0
    v_lshl_add_u32 v14, v14, 1, v0
    v_and_b32 v14, 7, v14
    v_lshlrev_b32 v14, 2, v14
    s_waitcnt lgkmcnt(7)
    v_mfma_f32_16x16x16_bf16 v[24:27], v[10:11], v[56:57], v[24:27]
    s_waitcnt lgkmcnt(6)
    v_mfma_f32_16x16x16_bf16 v[28:31], v[10:11], v[58:59], v[28:31]
    s_waitcnt lgkmcnt(5)
    v_mfma_f32_16x16x16_bf16 v[32:35], v[10:11], v[60:61], v[32:35]
    s_waitcnt lgkmcnt(4)
    v_mfma_f32_16x16x16_bf16 v[36:39], v[10:11], v[62:63], v[36:39]
    s_waitcnt lgkmcnt(3)
    v_mfma_f32_16x16x16_bf16 v[40:43], v[10:11], v[20:21], v[40:43]
    v_add_f32_dpp v16, v24, v25 quad_perm:[0,1,2,3] row_mask:1 bank_mask:0xf
    s_waitcnt lgkmcnt(2)
    v_mfma_f32_16x16x16_bf16 v[44:47], v[10:11], v[22:23], v[44:47]
    v_add_f32_dpp v16, v28, v29 quad_perm:[0,1,2,3] row_mask:2 bank_mask:0xf
    s_waitcnt lgkmcnt(1)
    v_mfma_f32_16x16x16_bf16 v[48:51], v[10:11], v[8:9], v[48:51]
    v_add_f32_dpp v16, v32, v33 quad_perm:[0,1,2,3] row_mask:4 bank_mask:0xf
    s_waitcnt lgkmcnt(0)
    v_mfma_f32_16x16x16_bf16 v[52:55], v[10:11], v[12:13], v[52:55]
    v_add_f32_dpp v16, v36, v37 quad_perm:[0,1,2,3] row_mask:8 bank_mask:0xf
    v_add_f32_dpp v17, v40, v41 quad_perm:[0,1,2,3] row_mask:1 bank_mask:0xf
    v_add_f32_dpp v17, v44, v45 quad_perm:[0,1,2,3] row_mask:2 bank_mask:0xf
    s_nop 1
    v_add_f32_dpp v17, v48, v49 quad_perm:[0,1,2,3] row_mask:4 bank_mask:0xf
    s_nop 1
    v_add_f32_dpp v17, v52, v53 quad_perm:[0,1,2,3] row_mask:8 bank_mask:0xf
    v_mul_f32 v44, s22, v16
    v_mul_f32 v45, s22, v17
    v_lshl_add_u32 v46, v0, 2, s68
    v_mov_b32 v47, v14
L_top_slow:
    ds_write2st64_b32 v46, v44, v45 offset0:26 offset1:27
    v_mov_b32 v10, 137728
    v_lshl_add_u32 v8, v0, 3, v10
    v_and_b32 v10, 56, v0
    v_lshlrev_b32 v10, 5, v10
    v_and_or_b32 v10, v6, 16, v10
    v_and_b32 v11, 6, v0
    v_lshl_or_b32 v10, v11, 1, v10
    s_cmp_lg_u32 s66, 0
    s_waitcnt lgkmcnt(0)
    s_barrier
    ds_read_b64 v[20:21], v8 offset:0
    ds_read_b64 v[22:23], v8 offset:8192
    ds_read_b64 v[24:25], v8 offset:16384
    ds_read_b64 v[26:27], v8 offset:24576
    buffer_load_dword v16, v47, s[52:55], s19 offen sc1
    s_cbranch_scc1 L_notw_500001
    s_waitcnt lgkmcnt(2)
    v_pk_add_f32 v[20:21], v[20:21], v[22:23]
    s_waitcnt lgkmcnt(0)
    v_pk_add_f32 v[24:25], v[24:25], v[26:27]
    v_pk_add_f32 v[20:21], v[20:21], v[24:25]
    v_cvt_pk_bf16_f32 v20, v20, v21
L_notw_500001:
    buffer_store_dword v20, v10, s[52:55], s17 offen sc1
    s_waitcnt lgkmcnt(0)
    s_mul_i32 s78, s74, s71
    s_cmp_eq_u32 s78, 3
    s_cbranch_scc1 L_res_500002
L_resback_500003:
    s_mul_i32 s78, s71, 393216
    s_add_u32 s56, s56, s78
    s_addc_u32 s57, s57, 0
    s_cmp_ge_u32 s65, 24
    s_cbranch_scc1 L_go_500007
    v_lshrrev_b32 v28, 4, v0
    v_bfe_u32 v29, v0, 2, 2
    v_lshl_add_u32 v28, v28, 3, v29
    v_mul_u32_u24 v28, 48, v28
    v_and_b32 v29, 3, v0
    v_lshl_add_u32 v28, v29, 3, v28
    v_add_u32 v28, s68, v28
    s_lshl_b32 s80, s66, 3
    s_add_u32 s80, s80, 146432
    s_waitcnt vmcnt(1)
    ds_read_b64_tr_b16 v[32:33], v28 offset:0
    ds_read_b64_tr_b16 v[34:35], v28 offset:192
    ds_read_b64_tr_b16 v[36:37], v28 offset:1536
    ds_read_b64_tr_b16 v[38:39], v28 offset:1728
    ds_read_b64_tr_b16 v[48:49], v28 offset:32
    ds_read_b64_tr_b16 v[50:51], v28 offset:224
    ds_read_b64_tr_b16 v[52:53], v28 offset:1568
    ds_read_b64_tr_b16 v[54:55], v28 offset:1760
L_chk_500009:
    v_cmp_eq_u32 vcc, -1, v16
    v_mov_b32 v22, v16
    s_cbranch_vccnz L_retry_500012
L_got_500011:
    buffer_load_dwordx4 v[8:11], v6, s[52:55], s21 offen sc1
    buffer_load_dwordx4 v[12:15], v6, s[52:55], s21 offen offset:1024 sc1
    ds_read_b64_tr_b16 v[40:41], v28 offset:3072
    v_max_f32_dpp v17, v22, v22 row_ror:4 row_mask:0xf bank_mask:0xf
    ds_read_b64_tr_b16 v[42:43], v28 offset:3264
    v_and_b32 v18, 15, v0
    ds_read_b64_tr_b16 v[44:45], v28 offset:4608
    v_max_f32_dpp v17, v17, v17 row_ror:2 row_mask:0xf bank_mask:0xf
    ds_read_b64_tr_b16 v[46:47], v28 offset:4800
    v_lshrrev_b32 v19, 5, v0
    ds_read_b64_tr_b16 v[56:57], v28 offset:3104
    v_max_f32_dpp v17, v17, v17 row_ror:1 row_mask:0xf bank_mask:0xf
    ds_read_b64_tr_b16 v[58:59], v28 offset:3296
    v_lshl_add_u32 v18, v19, 4, v18
    ds_read_b64_tr_b16 v[60:61], v28 offset:4640
    v_sub_f32 v22, v22, v17
    ds_read_b64_tr_b16 v[62:63], v28 offset:4832
    v_bfe_u32 v19, v0, 4, 1
    v_exp_f32 v22, v22
    v_lshlrev_b32 v19, 2, v19
    s_nop 0
    v_add_f32_dpp v17, v22, v22 row_ror:4 row_mask:0xf bank_mask:0xf
    v_lshl_add_u32 v18, v18, 5, v19
    s_nop 0
    v_add_f32_dpp v17, v17, v17 row_ror:2 row_mask:0xf bank_mask:0xf
    v_add_u32 v18, s80, v18
    s_nop 0
    v_add_f32_dpp v17, v17, v17 row_ror:1 row_mask:0xf bank_mask:0xf
    v_mov_b32 v19, 146432
    v_rcp_f32 v17, v17
    v_and_b32 v29, 15, v0
    s_nop 0
    v_mul_f32_dpp v30, v22, v17 row_newbcast:0 row_mask:0xf bank_mask:0xf
    v_lshl_add_u32 v19, v29, 6, v19
    v_mul_f32_dpp v31, v22, v17 row_newbcast:1 row_mask:0xf bank_mask:0xf
    v_lshlrev_b32 v29, 2, v0
    s_add_u32 s80, s96, 0
    v_lshrrev_b32 v28, 4, v0
    v_lshlrev_b32 v17, 5, v28
    v_xor_b32 v17, v17, v6
    s_lshl_b32 s79, s66, 7
    v_xor_b32 v17, s79, v17
    v_and_b32 v17, 0xf0, v17
    v_lshl_or_b32 v17, v28, 13, v17
L_poll_500013:
    buffer_load_dwordx4 v[8:11], v6, s[52:55], s21 offen sc1
    buffer_load_dwordx4 v[12:15], v6, s[52:55], s21 offen offset:1024 sc1
    v_mov_b64 v[26:27], 0
    v_mov_b64 v[24:25], 0
    v_mov_b64 v[22:23], 0
    v_mov_b64 v[20:21], 0
    s_waitcnt vmcnt(2) lgkmcnt(0)
    v_cmp_u_f32 vcc, v8, v12
    v_smfmac_f32_16x16x64_bf16 v[20:23], v[8:11], v[32:39], v1
    v_smfmac_f32_16x16x64_bf16 v[20:23], v[12:15], v[40:47], v1
    s_cbranch_vccnz L_retry_500015
L_got_500014:
    v_smfmac_f32_16x16x64_bf16 v[24:27], v[8:11], v[48:55], v1
    v_smfmac_f32_16x16x64_bf16 v[24:27], v[12:15], v[56:63], v1
    s_nop 4
    v_pk_mul_f32 v[20:21], v[20:21], v[30:31] op_sel_hi:[1,0]
    v_pk_fma_f32 v[20:21], v[22:23], v[30:31], v[20:21] op_sel:[0,1,0] op_sel_hi:[1,1,1]
    s_nop 0
    v_pk_mul_f32 v[24:25], v[24:25], v[30:31] op_sel_hi:[1,0]
    v_add_f32 v20, v20, v21
    v_pk_fma_f32 v[24:25], v[26:27], v[30:31], v[24:25] op_sel:[0,1,0] op_sel_hi:[1,1,1]
    v_add_f32 v24, v24, v25
    v_cmp_u_f32 vcc, v20, v20
    s_nop 0
    v_permlane32_swap_b32 v20, v24
    v_add_f32 v20, v20, v24
    ds_write_b32 v18, v20
    s_cbranch_vccnz L_retry_500017
L_got_500016:
    s_bitcmp0_b32 s74, 0
    s_waitcnt vmcnt(0) lgkmcnt(0)
    s_barrier
    s_cbranch_scc1 L_noy_500018
    ds_read_b128 v[32:35], v19 offset:0
    ds_read_b128 v[36:39], v19 offset:16
    ds_read_b128 v[40:43], v19 offset:32
    ds_read_b128 v[44:47], v19 offset:48
    s_mov_b32 exec_hi, 0
    s_waitcnt lgkmcnt(2)
    v_pk_add_f32 v[32:33], v[32:33], v[34:35]
    v_pk_add_f32 v[36:37], v[36:37], v[38:39]
    v_pk_add_f32 v[32:33], v[32:33], v[36:37]
    v_add_f32 v32, v32, v33
    s_waitcnt lgkmcnt(0)
    v_pk_add_f32 v[40:41], v[40:41], v[42:43]
    v_pk_add_f32 v[44:45], v[44:45], v[46:47]
    v_pk_add_f32 v[40:41], v[40:41], v[44:45]
    v_add_f32 v33, v40, v41
    v_pk_add_f32 v[32:33], v[32:33], v[4:5]
    v_cvt_pk_bf16_f32 v34, v32, v33
    buffer_store_dword v34, v29, s[56:59], s80 offen sc1
    s_mov_b32 exec_hi, -1
L_noy_500018:
    s_add_u32 m0, s68, 0
    s_add_u32 s79, s92, 0
    buffer_load_dwordx4 v17, s[32:35], s79 offen offset:0  lds
    s_add_u32 s79, s92, 31744
    buffer_load_dwordx4 v17, s[32:35], s79 offen offset:1024  lds
    s_add_u32 s79, s92, 63488
    buffer_load_dwordx4 v17, s[32:35], s79 offen offset:2048  lds
    s_add_u32 m0, s68, 3072
    s_add_u32 s79, s92, 98304
    buffer_load_dwordx4 v17, s[32:35], s79 offen offset:0  lds
    s_add_u32 s79, s92, 130048
    buffer_load_dwordx4 v17, s[32:35], s79 offen offset:1024  lds
    s_add_u32 s79, s92, 161792
    buffer_load_dwordx4 v17, s[32:35], s79 offen offset:2048  lds
    s_barrier
    s_cmp_eq_u32 s74, 3
    s_cselect_b64 vcc, -1, 0
    v_lshlrev_b32 v36, 16, v34
    v_and_b32 v37, 0xffff0000, v34
    v_pk_add_f32 v[32:33], v[32:33], v[36:37] neg_lo:[0,1] neg_hi:[0,1]
    v_cndmask_b32 v4, 0, v32, vcc
    v_cndmask_b32 v5, 0, v33, vcc
    v_mov_b32 v53, 0x3f803f80
    s_lshl_b64 s[82:83], s[84:85], 8
    v_cndmask_b32 v16, 0, v53, s[82:83]
    v_mov_b32 v17, v16
    v_mov_b64 v[18:19], v[16:17]
    v_mov_b64 v[20:21], v[16:17]
    v_mov_b64 v[22:23], v[16:17]
    v_mov_b64 v[24:25], v[16:17]
    v_mov_b64 v[26:27], v[16:17]
    v_lshrrev_b32 v12, 2, v0
    v_mul_u32_u24 v12, 3072, v12
    v_and_or_b32 v12, v6, 48, v12
    s_add_u32 s82, s86, 0
    s_add_u32 s83, s68, 6144
    v_lshrrev_b32 v52, 4, v0
    v_bfe_u32 v53, v0, 2, 2
    v_lshl_add_u32 v52, v52, 5, v53
    v_and_b32 v53, 31, v0
    v_lshlrev_b32 v53, 3, v53
    v_lshl_or_b32 v52, v52, 8, v53
    s_lshl_b32 s78, s66, 6
    s_add_u32 s78, s78, 131072
    v_xor_b32 v52, s78, v52
    v_xor_b32 v54, 32, v52
    v_lshlrev_b32 v14, 3, v0
    v_and_b32 v14, 16, v14
    v_and_or_b32 v14, v0, 12, v14
    v_and_b32 v15, 16, v0
    v_lshl_or_b32 v14, v15, 4, v14
    v_and_b32 v15, 32, v0
    v_lshl_or_b32 v14, v15, 6, v14
    v_lshrrev_b32 v15, 1, v0
    s_mov_b32 vcc_lo, 2863311530
    s_mov_b32 vcc_hi, 2863311530
    v_cndmask_b32 v14, v14, 2.0, vcc
    s_sub_u32 s78, s89, s88
    s_add_u32 s78, s78, 256
    v_writelane_b32 v14, s78, 1
    s_add_u32 s78, s78, 4
    v_writelane_b32 v14, s78, 9
    s_mov_b64 s[22:23], 0x202
    v_and_b32 v11, 48, v0
    v_lshlrev_b32 v11, 3, v11
    v_and_or_b32 v11, v0, 7, v11
    v_lshlrev_b32 v11, 6, v11
    v_add_u32 v11, 137216, v11
    v_mov_b32 v13, 0
    v_lshrrev_b32 v9, 4, v0
    v_lshlrev_b32 v8, 5, v9
    v_xor_b32 v8, v8, v6
    v_and_b32 v8, 0xf0, v8
    v_lshl_or_b32 v8, v9, 13, v8
    s_cmp_eq_u32 s71, 0
    s_cbranch_scc1 L_go_500019
    s_sleep 6
L_back_500020:
    s_mov_b32 m0, s83
    s_mov_b64 exec, 0x77777777
    buffer_load_dword v13, v12, s[56:59], s82 offen sc1
    buffer_load_dwordx4 v12, s[56:59], s82 offen sc1 lds
    s_mov_b64 exec, -1
    v_lshlrev_b32 v60, 7, v0
    s_lshl_b32 s79, s64, 17
    s_lshl_b32 s78, s65, 12
    s_add_u32 s79, s79, s78
    s_lshl_b32 s78, s66, 10
    s_add_u32 s79, s79, s78
    s_mov_b32 exec_lo, 255
    s_mov_b32 exec_hi, 0
    buffer_load_dword v10, v60, s[48:51], s79 offen
    s_mov_b64 exec, -1
    s_lshl_b32 s79, s65, 10
    s_lshl_b32 s78, s66, 8
    s_add_u32 s79, s79, s78
    v_lshl_add_u32 v60, v0, 7, s79
    v_min_u32 v60, L_tailend-L_top_fast, v60
    s_getpc_b64 s[78:79]
L_pc_500022:
    s_add_u32 s78, s78, L_top_fast-L_pc_500022
    s_addc_u32 s79, s79, -1
    s_mov_b64 exec, 3
    global_load_dword v10, v60, s[78:79]
    s_mov_b64 exec, -1
    s_waitcnt vmcnt(4)
    s_barrier
    ds_read_b64_tr_b16 v[28:29], v52 offset:0
    ds_read_b64_tr_b16 v[30:31], v52 offset:1024
    ds_read_b64_tr_b16 v[32:33], v54 offset:0
    ds_read_b64_tr_b16 v[34:35], v54 offset:1024
    ds_read_b64_tr_b16 v[36:37], v52 offset:2048
    ds_read_b64_tr_b16 v[38:39], v52 offset:3072
    ds_read_b64_tr_b16 v[40:41], v54 offset:2048
    ds_read_b64_tr_b16 v[42:43], v54 offset:3072
    ds_read_b64_tr_b16 v[44:45], v52 offset:4096
    ds_read_b64_tr_b16 v[46:47], v52 offset:5120
    ds_read_b64_tr_b16 v[48:49], v54 offset:4096
    ds_read_b64_tr_b16 v[50:51], v54 offset:5120
    s_waitcnt lgkmcnt(0)
    s_barrier
    s_mov_b32 m0, s68
    s_add_u32 s79, s94, 0
    buffer_load_dwordx4 v8, s[36:39], s79 offen offset:0  lds
    s_add_u32 s79, s94, 31744
    v_xor_b32 v9, 128, v8
    buffer_load_dwordx4 v9, s[36:39], s79 offen offset:1024  lds
    s_add_u32 s79, s94, 63488
    v_xor_b32 v9, 144, v8
    buffer_load_dwordx4 v9, s[36:39], s79 offen offset:2048  lds
    s_add_u32 s79, s94, 95232
    v_xor_b32 v9, 16, v8
    buffer_load_dwordx4 v9, s[36:39], s79 offen offset:3072  lds
    s_waitcnt vmcnt(7)
L_chk_500023:
    v_cmp_eq_u32 vcc, -1, v13
    s_waitcnt vmcnt(6)
    s_cbranch_vccnz L_retry_500026
L_got_500025:
    s_mov_b64 exec, s[84:85]
    s_barrier
    ds_read_b128 v[16:19], v11 offset:0
    ds_read_b128 v[20:23], v11 offset:16
    ds_read_b128 v[24:27], v11 offset:32
    s_mov_b64 exec, -1
    s_waitcnt lgkmcnt(2)
    v_mfma_f32_16x16x32_bf16 v[60:63], v[16:19], v[16:19], 0
    s_waitcnt lgkmcnt(1)
    v_mfma_f32_16x16x32_bf16 v[60:63], v[20:23], v[20:23], v[60:63]
    s_waitcnt lgkmcnt(0)
    v_mfma_f32_16x16x32_bf16 v[60:63], v[24:27], v[24:27], v[60:63]
    v_mfma_f32_16x16x32_bf16 v[52:55], v[16:19], v[28:31], 0
    s_nop 1
    v_mfma_f32_16x16x32_bf16 v[52:55], v[20:23], v[36:39], v[52:55]
    s_nop 1
    v_mfma_f32_16x16x32_bf16 v[52:55], v[24:27], v[44:47], v[52:55]
    s_nop 0
    v_pk_add_f32 v[60:61], v[60:61], v[62:63]
    v_mfma_f32_16x16x32_bf16 v[56:59], v[16:19], v[32:35], 0
    v_add_f32 v62, v60, v61
    v_add_f32 v60, v60, v61
    v_mfma_f32_16x16x32_bf16 v[56:59], v[20:23], v[40:43], v[56:59]
    v_cmp_u_f32 vcc, v62, v62
    v_permlane16_swap_b32 v60, v62
    v_mfma_f32_16x16x32_bf16 v[56:59], v[24:27], v[48:51], v[56:59]
    v_add_f32 v60, v60, v62
    v_pk_add_f32 v[52:53], v[52:53], v[54:55]
    v_add_f32 v52, v52, v53
    v_add_f32_dpp v60, v60, v60 quad_perm:[1,0,3,2] row_mask:0xf bank_mask:0xf
    s_nop 1
    v_add_f32_dpp v60, v60, v60 quad_perm:[2,3,0,1] row_mask:0xf bank_mask:0xf
    s_nop 0
    v_pk_add_f32 v[56:57], v[56:57], v[58:59]
    v_add_f32 v56, v56, v57
    v_add_f32_dpp v60, v60, v60 row_half_mirror row_mask:0xf bank_mask:0xf
    s_cbranch_vccnz L_retry_500029
L_got_500028:
    v_permlane16_swap_b32 v52, v56
    v_add_f32 v52, v52, v56
    s_nop 1
    v_mov_b32_dpp v53, v52 quad_perm:[1,0,3,2] row_mask:0xf bank_mask:0xf
    v_cvt_pk_bf16_f32 v52, v52, v53
    v_cndmask_b32 v52, v52, v60, s[22:23]
    buffer_store_dword v52, v14, s[52:55], s88 offen sc1
L_back_500008:
    s_sub_u32 s78, s68, s69
    v_add_u32 v56, s78, v3
    v_xor_b32 v57, 64, v56
    v_xor_b32 v58, 128, v56
    v_xor_b32 v59, 192, v56
    v_and_b32 v36, 7, v0
    v_lshlrev_b32 v37, 3, v36
    s_mov_b32 vcc_lo, 3233857728
    s_mov_b32 vcc_hi, 3233857728
    v_cndmask_b32 v37, v37, 2.0, vcc
    s_mov_b32 vcc_lo, 4026593280
    s_mov_b32 vcc_hi, 4026593280
    v_cndmask_b32 v33, v6, 2.0, vcc
    s_waitcnt vmcnt(1)
    ds_read_b128 v[40:43], v56
    v_mov_b64 v[16:17], 0
    ds_read_b128 v[44:47], v57
    v_mov_b64 v[18:19], 0
    ds_read_b128 v[48:51], v58
    v_mov_b64 v[20:21], 0
    ds_read_b128 v[52:55], v59
    v_mov_b64 v[22:23], 0
L_poll_500036:
    s_cmp_eq_u32 s71, 0
    s_cbranch_scc1 L_cs_500037
L_csb_500038:
    buffer_load_dwordx2 v[34:35], v37, s[52:55], s5 offen sc1
    buffer_load_dwordx4 v[8:11], v33, s[52:55], s4 offen offset:0 sc1
    buffer_load_dwordx4 v[12:15], v33, s[52:55], s4 offen offset:1024 sc1
    v_mov_b64 v[24:25], 0
    v_mov_b64 v[26:27], 0
    v_mov_b64 v[28:29], 0
    v_mov_b64 v[30:31], 0
    v_and_b32 v38, 8, v0
    v_lshlrev_b32 v38, 3, v38
    v_lshl_or_b32 v38, v36, 1, v38
    s_lshl_b32 s78, s66, 4
    s_add_u32 s78, s78, 154624
    v_add_u32 v38, s78, v38
    v_add_u32 v39, 154624, v6
    v_mov_b32 v32, 0x4575fdf0
    s_cmp_lg_u32 s66, 0
    s_waitcnt vmcnt(3) lgkmcnt(0)
    v_smfmac_f32_16x16x64_bf16 v[28:31], v[16:19], v[40:47], v1
    v_smfmac_f32_16x16x64_bf16 v[28:31], v[20:23], v[48:55], v1
    s_waitcnt vmcnt(2)
    v_cmp_u_f32 vcc, v34, v35
    v_add_f32_dpp v35, v35, v35 row_ror:4 row_mask:0xf bank_mask:0xf
    v_add_f32_dpp v34, v34, v34 row_ror:4 row_mask:0xf bank_mask:0xf
    s_nop 0
    v_add_f32_dpp v35, v35, v35 row_ror:2 row_mask:0xf bank_mask:0xf
    v_add_f32_dpp v34, v34, v34 row_ror:2 row_mask:0xf bank_mask:0xf
    s_cbranch_vccnz L_retry_500040
L_got_500039:
    s_waitcnt vmcnt(1)
    v_smfmac_f32_16x16x64_bf16 v[24:27], v[8:11], v[40:47], v1
    v_add_f32_dpp v35, v35, v35 row_ror:1 row_mask:0xf bank_mask:0xf
    v_add_f32_dpp v34, v34, v34 row_ror:1 row_mask:0xf bank_mask:0xf
    v_pk_add_f32 v[28:29], v[28:29], v[30:31]
    v_mul_f32 v35, 0x37e38e39, v35
    s_waitcnt vmcnt(0)
    v_smfmac_f32_16x16x64_bf16 v[24:27], v[12:15], v[48:55], v1
    v_mul_f32 v34, 0x37e38e39, v34
    v_add_f32 v28, v28, v29
    v_fma_f32 v34, -v35, v35, v34
    v_max_f32 v34, 0, v34
    v_add_f32 v30, v28, v7
    v_fmaak_f32 v34, v32, v34, 0x3a21369a
    v_rsq_f32 v34, v34
    v_mul_f32 v28, v30, v35
    v_pk_add_f32 v[24:25], v[24:25], v[26:27]
    v_sub_f32 v24, v24, v28
    v_add_f32 v24, v24, v25
    v_mul_f32 v25, v24, v34
    v_mul_f32 v24, v24, v34
    v_cmp_u_f32 vcc, v24, v24
    s_nop 0
    v_permlane32_swap_b32 v24, v25
    v_add_f32 v26, v24, v25
    v_add_f32 v24, v24, v25
    s_nop 1
    v_permlane16_swap_b32 v24, v26
    v_add_f32 v24, v24, v26
    v_cvt_pk_bf16_f32 v24, v24, v24
    ds_write_b16 v38, v24
    s_cbranch_vccnz L_retry_500042
L_got_500041:
    v_mov_b32 v7, v30
    s_waitcnt lgkmcnt(0)
    s_barrier
    s_cbranch_scc1 L_notw_500043
    s_mov_b64 exec, 0xff
    ds_read_b128 v[24:27], v39
    s_waitcnt lgkmcnt(0)
    buffer_store_dwordx4 v[24:27], v6, s[56:59], s6 offen sc1
    s_mov_b64 exec, -1
L_notw_500043:
    s_cmp_eq_u32 s74, 3
    s_cbranch_scc1 L_res_500044
L_resback_500045:
    s_mul_i32 s78, s66, -12288
    s_add_u32 s78, s78, 65536
    v_add_u32 v56, s78, v3
    v_xor_b32 v57, 64, v56
    v_and_b32 v58, 12, v0
    v_lshlrev_b32 v58, 4, v58
    v_and_or_b32 v58, v0, 48, v58
    v_lshlrev_b32 v58, 2, v58
    v_and_or_b32 v58, v6, 48, v58
    v_lshlrev_b32 v8, 7, v0
    v_mov_b32 v9, 0
    v_add_u32 v59, 131072, v6
    s_barrier
    s_cmp_eq_u32 s71, 0
    s_cbranch_scc1 L_go_500049
    v_mov_b32 v12, -1
    v_mov_b32 v13, -1
    v_mov_b32 v14, -1
    v_mov_b32 v15, -1
    v_lshrrev_b32 v16, 4, v0
    v_and_b32 v17, 0xf0, v6
    v_lshl_or_b32 v16, v16, 16, v17
    s_add_u32 s79, s8, 0
    buffer_store_dwordx4 v[12:15], v16, s[48:51], s79 offen sc1
    s_add_u32 s79, s8, 4096
    buffer_store_dwordx4 v[12:15], v16, s[48:51], s79 offen sc1
    s_add_u32 s79, s8, 8192
    buffer_store_dwordx4 v[12:15], v16, s[48:51], s79 offen sc1
    s_add_u32 s79, s8, 12288
    buffer_store_dwordx4 v[12:15], v16, s[48:51], s79 offen sc1
    s_sleep 6
L_back_500050:
L_poll_500055:
    s_mov_b32 m0, s68
    s_mov_b32 exec_lo, 4294967295
    s_mov_b32 exec_hi, 0
    buffer_load_dword v9, v8, s[56:59], s7 offen sc1
    s_mov_b64 exec, -1
    buffer_load_dwordx4 v58, s[56:59], s7 offen offset:0 sc1 lds
    buffer_load_dwordx4 v58, s[56:59], s7 offen offset:1024 sc1 lds
    buffer_load_dwordx4 v58, s[56:59], s7 offen offset:2048 sc1 lds
    buffer_load_dwordx4 v58, s[56:59], s7 offen offset:3072 sc1 lds
    ds_read_b128 v[24:27], v56 offset:0
    ds_read_b128 v[28:31], v57 offset:0
    ds_read_b128 v[32:35], v56 offset:16384
    ds_read_b128 v[36:39], v57 offset:16384
    ds_read_b128 v[40:43], v56 offset:32768
    ds_read_b128 v[44:47], v57 offset:32768
    ds_read_b128 v[48:51], v56 offset:49152
    ds_read_b128 v[52:55], v57 offset:49152
    v_xor_b32 v56, 128, v56
    v_xor_b32 v57, 128, v57
    v_lshrrev_b32 v10, 2, v0
    v_lshlrev_b32 v10, 13, v10
    v_and_or_b32 v10, v6, 48, v10
L_chk_500056:
    s_waitcnt vmcnt(4)
    v_cmp_eq_u32 vcc, -1, v9
    s_cbranch_vccnz L_retry_500059
L_got_500058:
    s_add_u32 s79, s95, 130048
    s_add_u32 s80, s95, 260096
    s_add_u32 s81, s95, 390144
    v_mov_b32 v58, v10
    s_waitcnt vmcnt(2) lgkmcnt(0)
    s_barrier
    ds_read_b128 v[8:11], v59 offset:0
    ds_read_b128 v[12:15], v59 offset:1024
    ds_read_b128 v[16:19], v59 offset:8192
    ds_read_b128 v[20:23], v59 offset:9216
    s_add_u32 m0, s68, 4096
    s_waitcnt lgkmcnt(3)
    v_mfma_f32_16x16x32_bf16 v[60:63], v[24:27], v[8:11], 0
    ds_read_b128 v[24:27], v56 offset:0
    ds_read_b128 v[8:11], v59 offset:16384
    s_waitcnt lgkmcnt(4)
    v_mfma_f32_16x16x32_bf16 v[60:63], v[28:31], v[12:15], v[60:63]
    ds_read_b128 v[28:31], v57 offset:0
    ds_read_b128 v[12:15], v59 offset:17408
    buffer_load_dwordx4 v58, s[40:43], s95 offen offset:0  lds
    s_waitcnt lgkmcnt(5)
    v_mfma_f32_16x16x32_bf16 v[60:63], v[32:35], v[16:19], v[60:63]
    ds_read_b128 v[32:35], v56 offset:16384
    ds_read_b128 v[16:19], v59 offset:24576
    s_waitcnt lgkmcnt(6)
    v_mfma_f32_16x16x32_bf16 v[60:63], v[36:39], v[20:23], v[60:63]
    ds_read_b128 v[36:39], v57 offset:16384
    ds_read_b128 v[20:23], v59 offset:25600
    buffer_load_dwordx4 v58, s[40:43], s79 offen offset:1024  lds
    s_waitcnt lgkmcnt(6)
    v_mfma_f32_16x16x32_bf16 v[60:63], v[40:43], v[8:11], v[60:63]
    ds_read_b128 v[40:43], v56 offset:32768
    s_waitcnt vmcnt(2)
    s_barrier
    ds_read_b128 v[8:11], v59 offset:2048
    s_waitcnt lgkmcnt(6)
    v_mfma_f32_16x16x32_bf16 v[60:63], v[44:47], v[12:15], v[60:63]
    ds_read_b128 v[44:47], v57 offset:32768
    ds_read_b128 v[12:15], v59 offset:3072
    buffer_load_dwordx4 v58, s[40:43], s80 offen offset:2048  lds
    s_waitcnt lgkmcnt(6)
    v_mfma_f32_16x16x32_bf16 v[60:63], v[48:51], v[16:19], v[60:63]
    ds_read_b128 v[48:51], v56 offset:49152
    ds_read_b128 v[16:19], v59 offset:10240
    s_waitcnt lgkmcnt(6)
    v_mfma_f32_16x16x32_bf16 v[60:63], v[52:55], v[20:23], v[60:63]
    ds_read_b128 v[52:55], v57 offset:49152
    ds_read_b128 v[20:23], v59 offset:11264
    buffer_load_dwordx4 v58, s[40:43], s81 offen offset:3072  lds
    s_waitcnt lgkmcnt(6)
    v_mfma_f32_16x16x32_bf16 v[60:63], v[24:27], v[8:11], v[60:63]
    ds_read_b128 v[8:11], v59 offset:18432
    v_and_b32 v27, 0xf0, v6
    s_lshl_b32 s78, s66, 2
    s_waitcnt lgkmcnt(5)
    v_mfma_f32_16x16x32_bf16 v[60:63], v[28:31], v[12:15], v[60:63]
    ds_read_b128 v[12:15], v59 offset:19456
    v_add_u32 v27, 131072, v27
    s_waitcnt lgkmcnt(4)
    v_mfma_f32_16x16x32_bf16 v[60:63], v[32:35], v[16:19], v[60:63]
    ds_read_b128 v[16:19], v59 offset:26624
    s_barrier
    s_waitcnt lgkmcnt(3)
    v_mfma_f32_16x16x32_bf16 v[60:63], v[36:39], v[20:23], v[60:63]
    ds_read_b128 v[20:23], v59 offset:27648
    v_add_u32 v24, s78, v27
    s_waitcnt lgkmcnt(3)
    v_mfma_f32_16x16x32_bf16 v[60:63], v[40:43], v[8:11], v[60:63]
    v_xor_b32 v56, 128, v56
    v_lshl_add_u32 v25, v0, 3, s68
    s_waitcnt lgkmcnt(2)
    v_mfma_f32_16x16x32_bf16 v[60:63], v[44:47], v[12:15], v[60:63]
    v_xor_b32 v57, 65568, v2
    ds_read_b64_tr_b16 v[40:41], v57 offset:0
    s_waitcnt lgkmcnt(2)
    v_mfma_f32_16x16x32_bf16 v[60:63], v[48:51], v[16:19], v[60:63]
    ds_read_b64_tr_b16 v[42:43], v57 offset:4096
    ds_read_b64_tr_b16 v[44:45], v57 offset:8192
    s_waitcnt lgkmcnt(3)
    v_mfma_f32_16x16x32_bf16 v[60:63], v[52:55], v[20:23], v[60:63]
    ds_read_b64_tr_b16 v[46:47], v57 offset:12288
    v_mov_b32 v26, 131072
    v_lshl_add_u32 v26, v0, 3, v26
    v_mov_b32 v36, 0x3f803f80
    v_mov_b32 v37, 0x3f803f80
    v_mov_b32 v38, 0x3f803f80
    v_mov_b32 v39, 0x3f803f80
    s_nop 0
    v_max3_f32 v28, v60, v61, v62
    v_max_f32 v29, v28, v63
    v_max_f32 v28, v28, v63
    v_xor_b32 v57, 65536, v2
    ds_read_b64_tr_b16 v[16:17], v57 offset:0
    v_permlane32_swap_b32 v28, v29
    v_max_f32 v30, v28, v29
    v_max_f32 v28, v28, v29
    ds_read_b64_tr_b16 v[18:19], v57 offset:4096
    ds_read_b64_tr_b16 v[20:21], v57 offset:8192
    v_permlane16_swap_b32 v28, v30
    v_max_f32 v28, v28, v30
    ds_write_b32 v24, v28
    ds_read_b64_tr_b16 v[22:23], v57 offset:12288
    v_xor_b32 v57, 65600, v2
    ds_read_b64_tr_b16 v[48:49], v57 offset:0
    ds_read_b64_tr_b16 v[50:51], v57 offset:4096
    ds_read_b64_tr_b16 v[52:53], v57 offset:8192
    ds_read_b64_tr_b16 v[54:55], v57 offset:12288
    s_waitcnt lgkmcnt(5)
    s_barrier
    ds_read_b128 v[28:31], v27
    s_add_u32 s79, s8, 4096
    s_add_u32 s80, s8, 8192
    s_add_u32 s81, s8, 12288
    s_waitcnt lgkmcnt(0)
    v_max3_f32 v28, v28, v29, v30
    v_max_f32 v28, v28, v31
    v_pk_add_f32 v[60:61], v[60:61], v[28:29] op_sel_hi:[1,0] neg_lo:[0,1] neg_hi:[0,1]
    v_pk_add_f32 v[62:63], v[62:63], v[28:29] op_sel_hi:[1,0] neg_lo:[0,1] neg_hi:[0,1]
    v_exp_f32 v60, v60
    v_exp_f32 v61, v61
    v_exp_f32 v62, v62
    v_exp_f32 v63, v63
    v_cvt_pk_bf16_f32 v30, v60, v61
    v_cvt_pk_bf16_f32 v31, v62, v63
    ds_write_b64 v25, v[30:31] offset:1024
    v_lshrrev_b32 v61, 4, v0
    v_and_b32 v60, 0xf0, v6
    v_lshl_or_b32 v61, v61, 16, v60
    v_mov_b32 v62, v28
    v_xor_b32 v57, 64, v56
    v_and_b32 v27, 12, v0
    v_lshlrev_b32 v27, 2, v27
    s_waitcnt lgkmcnt(0)
    s_barrier
    ds_read2st64_b64 v[8:11], v26 offset0:2 offset1:18
    ds_read2st64_b64 v[12:15], v26 offset0:34 offset1:50
    v_and_or_b32 v27, v0, 3, v27
    v_lshlrev_b32 v27, 5, v27
    v_and_b32 v60, 48, v0
    v_lshl_or_b32 v27, v60, 20, v27
    s_waitcnt lgkmcnt(1)
    v_cmp_u_f32 vcc, v8, v8
    v_mfma_f32_16x16x32_bf16 v[28:31], v[8:11], v[16:19], 0
    v_mfma_f32_16x16x32_bf16 v[32:35], v[36:39], v[8:11], 0
    s_cbranch_vccnz L_retry_500062
L_got_500061:
    s_waitcnt lgkmcnt(0)
    v_mfma_f32_16x16x32_bf16 v[32:35], v[36:39], v[12:15], v[32:35]
    v_xor_b32 v60, 65632, v2
    ds_read_b64_tr_b16 v[16:17], v60 offset:0
    ds_read_b64_tr_b16 v[18:19], v60 offset:4096
    v_mfma_f32_16x16x32_bf16 v[28:31], v[12:15], v[20:23], v[28:31]
    ds_read_b64_tr_b16 v[20:21], v60 offset:8192
    ds_read_b64_tr_b16 v[22:23], v60 offset:12288
    v_xor_b32 v60, 65664, v2
    v_mfma_f32_16x16x32_bf16 v[56:59], v[8:11], v[40:43], 0
    ds_read_b64_tr_b16 v[40:41], v60 offset:0
    ds_read_b64_tr_b16 v[42:43], v60 offset:4096
    v_mfma_f32_16x16x32_bf16 v[56:59], v[12:15], v[44:47], v[56:59]
    ds_read_b64_tr_b16 v[44:45], v60 offset:8192
    ds_read_b64_tr_b16 v[46:47], v60 offset:12288
    v_mov_b32 v63, v32
    buffer_store_dwordx2 v[62:63], v27, s[52:55], s9 offen sc1
    v_xor_b32 v60, 65696, v2
    v_mfma_f32_16x16x32_bf16 v[36:39], v[8:11], v[48:51], 0
    ds_read_b64_tr_b16 v[48:49], v60 offset:0
    ds_read_b64_tr_b16 v[50:51], v60 offset:4096
    v_mfma_f32_16x16x32_bf16 v[36:39], v[12:15], v[52:55], v[36:39]
    ds_read_b64_tr_b16 v[52:53], v60 offset:8192
    ds_read_b64_tr_b16 v[54:55], v60 offset:12288
    s_waitcnt lgkmcnt(8)
    v_xor_b32 v60, 65728, v2
    v_mfma_f32_16x16x32_bf16 v[32:35], v[8:11], v[16:19], 0
    ds_read_b64_tr_b16 v[16:17], v60 offset:0
    ds_read_b64_tr_b16 v[18:19], v60 offset:4096
    v_cvt_pk_bf16_f32 v24, v28, v56
    v_cvt_pk_bf16_f32 v25, v29, v57
    v_mfma_f32_16x16x32_bf16 v[32:35], v[12:15], v[20:23], v[32:35]
    ds_read_b64_tr_b16 v[20:21], v60 offset:8192
    ds_read_b64_tr_b16 v[22:23], v60 offset:12288
    v_cvt_pk_bf16_f32 v26, v30, v58
    v_cvt_pk_bf16_f32 v27, v31, v59
    s_waitcnt lgkmcnt(8)
    v_xor_b32 v60, 65760, v2
    v_mfma_f32_16x16x32_bf16 v[28:31], v[8:11], v[40:43], 0
    buffer_store_dwordx4 v[24:27], v61, s[48:51], s8 offen sc1
    ds_read_b64_tr_b16 v[40:41], v60 offset:0
    ds_read_b64_tr_b16 v[42:43], v60 offset:4096
    v_mfma_f32_16x16x32_bf16 v[28:31], v[12:15], v[44:47], v[28:31]
    ds_read_b64_tr_b16 v[44:45], v60 offset:8192
    ds_read_b64_tr_b16 v[46:47], v60 offset:12288
    s_waitcnt lgkmcnt(8)
    v_mfma_f32_16x16x32_bf16 v[56:59], v[8:11], v[48:51], 0
    v_cvt_pk_bf16_f32 v24, v36, v32
    v_cvt_pk_bf16_f32 v25, v37, v33
    v_mfma_f32_16x16x32_bf16 v[56:59], v[12:15], v[52:55], v[56:59]
    v_cvt_pk_bf16_f32 v26, v38, v34
    v_cvt_pk_bf16_f32 v27, v39, v35
    s_waitcnt lgkmcnt(4)
    v_mfma_f32_16x16x32_bf16 v[36:39], v[8:11], v[16:19], 0
    buffer_store_dwordx4 v[24:27], v61, s[48:51], s79 offen sc1
    v_lshlrev_b32 v60, 3, v0
    v_mfma_f32_16x16x32_bf16 v[36:39], v[12:15], v[20:23], v[36:39]
    s_waitcnt lgkmcnt(0)
    v_mfma_f32_16x16x32_bf16 v[32:35], v[8:11], v[40:43], 0
    v_cvt_pk_bf16_f32 v24, v28, v56
    v_cvt_pk_bf16_f32 v25, v29, v57
    v_cvt_pk_bf16_f32 v26, v30, v58
    v_cvt_pk_bf16_f32 v27, v31, v59
    v_mfma_f32_16x16x32_bf16 v[32:35], v[12:15], v[44:47], v[32:35]
    buffer_store_dwordx4 v[24:27], v61, s[48:51], s80 offen sc1
    s_nop 6
    v_cvt_pk_bf16_f32 v24, v36, v32
    v_cvt_pk_bf16_f32 v25, v37, v33
    v_cvt_pk_bf16_f32 v26, v38, v34
    v_cvt_pk_bf16_f32 v27, v39, v35
    buffer_store_dwordx4 v[24:27], v61, s[48:51], s81 offen sc1
    buffer_load_dwordx2 v[22:23], v60, s[52:55], s11 offen sc1
    v_and_b32 v45, 56, v0
    v_lshlrev_b32 v45, 1, v45
    v_and_or_b32 v45, v0, 6, v45
    v_lshlrev_b32 v45, 1, v45
    v_and_or_b32 v45, v6, 16, v45
    v_lshlrev_b32 v46, 2, v0
    s_mov_b32 vcc_lo, 0
    s_mov_b32 vcc_hi, 4294967295
    v_cndmask_b32 v46, v46, 2.0, vcc
    v_mov_b64 v[28:29], 0
    v_mov_b64 v[30:31], 0
    v_mov_b64 v[32:33], 0
    v_mov_b64 v[34:35], 0
    s_waitcnt vmcnt(0)
L_chk_500063:
    v_cmp_u_f32 vcc, v22, v23
    v_max_f32_dpp v36, v22, v22 quad_perm:[1,0,3,2] row_mask:0xf bank_mask:0xf
    v_mov_b64 v[24:25], v[22:23]
    s_cbranch_vccnz L_retry_500066
L_got_500065:
    v_max_f32_dpp v37, v36, v36 quad_perm:[2,3,0,1] row_mask:0xf bank_mask:0xf
    v_max_f32_dpp v36, v36, v36 quad_perm:[2,3,0,1] row_mask:0xf bank_mask:0xf
    s_nop 1
    v_permlane32_swap_b32 v36, v37
    v_max_f32 v38, v36, v37
    v_max_f32 v36, v36, v37
    s_nop 1
    v_permlane16_swap_b32 v36, v38
    v_max_f32 v36, v36, v38
    buffer_load_dwordx4 v[8:11], v6, s[48:51], s10 offen offset:0 sc1
    buffer_load_dwordx4 v[12:15], v6, s[48:51], s10 offen offset:1024 sc1
    buffer_load_dwordx4 v[16:19], v6, s[48:51], s10 offen offset:2048 sc1
    buffer_load_dwordx4 v[20:23], v6, s[48:51], s10 offen offset:3072 sc1
    v_sub_f32 v24, v24, v36
    v_exp_f32 v24, v24
    s_nop 0
    v_mul_f32 v25, v25, v24
    s_nop 1
    v_add_f32_dpp v25, v25, v25 quad_perm:[1,0,3,2] row_mask:0xf bank_mask:0xf
    s_nop 1
    v_add_f32_dpp v37, v25, v25 quad_perm:[2,3,0,1] row_mask:0xf bank_mask:0xf
    v_add_f32_dpp v25, v25, v25 quad_perm:[2,3,0,1] row_mask:0xf bank_mask:0xf
    s_nop 1
    v_permlane32_swap_b32 v25, v37
    v_add_f32 v38, v25, v37
    v_add_f32 v25, v25, v37
    s_nop 1
    v_permlane16_swap_b32 v25, v38
    v_add_f32 v25, v25, v38
    v_rcp_f32 v38, v25
    v_log_f32 v37, v25
    v_mul_f32 v24, v24, v38
    v_add_f32 v37, v37, v36
    v_cvt_pk_bf16_f32 v26, v24, 0
    v_cvt_pk_bf16_f32 v27, 0, v24
    buffer_store_dword v37, v46, s[56:59], s13 offen sc1
L_acc_500067:
    s_waitcnt vmcnt(4)
    v_dot2c_f32_bf16_dpp v28, v26, v8 row_newbcast:0 row_mask:0xf bank_mask:0xf
    v_dot2c_f32_bf16_dpp v29, v27, v8 row_newbcast:0 row_mask:0xf bank_mask:0xf
    v_dot2c_f32_bf16_dpp v30, v26, v9 row_newbcast:4 row_mask:0xf bank_mask:0xf
    v_dot2c_f32_bf16_dpp v31, v27, v9 row_newbcast:4 row_mask:0xf bank_mask:0xf
    v_dot2c_f32_bf16_dpp v32, v26, v10 row_newbcast:8 row_mask:0xf bank_mask:0xf
    v_dot2c_f32_bf16_dpp v33, v27, v10 row_newbcast:8 row_mask:0xf bank_mask:0xf
    v_dot2c_f32_bf16_dpp v34, v26, v11 row_newbcast:12 row_mask:0xf bank_mask:0xf
    v_dot2c_f32_bf16_dpp v35, v27, v11 row_newbcast:12 row_mask:0xf bank_mask:0xf
    s_waitcnt vmcnt(3)
    v_dot2c_f32_bf16_dpp v28, v26, v12 row_newbcast:1 row_mask:0xf bank_mask:0xf
    v_dot2c_f32_bf16_dpp v29, v27, v12 row_newbcast:1 row_mask:0xf bank_mask:0xf
    v_dot2c_f32_bf16_dpp v30, v26, v13 row_newbcast:5 row_mask:0xf bank_mask:0xf
    v_dot2c_f32_bf16_dpp v31, v27, v13 row_newbcast:5 row_mask:0xf bank_mask:0xf
    v_dot2c_f32_bf16_dpp v32, v26, v14 row_newbcast:9 row_mask:0xf bank_mask:0xf
    v_dot2c_f32_bf16_dpp v33, v27, v14 row_newbcast:9 row_mask:0xf bank_mask:0xf
    v_dot2c_f32_bf16_dpp v34, v26, v15 row_newbcast:13 row_mask:0xf bank_mask:0xf
    v_dot2c_f32_bf16_dpp v35, v27, v15 row_newbcast:13 row_mask:0xf bank_mask:0xf
    s_waitcnt vmcnt(2)
    v_dot2c_f32_bf16_dpp v28, v26, v16 row_newbcast:2 row_mask:0xf bank_mask:0xf
    v_dot2c_f32_bf16_dpp v29, v27, v16 row_newbcast:2 row_mask:0xf bank_mask:0xf
    v_dot2c_f32_bf16_dpp v30, v26, v17 row_newbcast:6 row_mask:0xf bank_mask:0xf
    v_dot2c_f32_bf16_dpp v31, v27, v17 row_newbcast:6 row_mask:0xf bank_mask:0xf
    v_dot2c_f32_bf16_dpp v32, v26, v18 row_newbcast:10 row_mask:0xf bank_mask:0xf
    v_dot2c_f32_bf16_dpp v33, v27, v18 row_newbcast:10 row_mask:0xf bank_mask:0xf
    v_dot2c_f32_bf16_dpp v34, v26, v19 row_newbcast:14 row_mask:0xf bank_mask:0xf
    v_dot2c_f32_bf16_dpp v35, v27, v19 row_newbcast:14 row_mask:0xf bank_mask:0xf
    s_waitcnt vmcnt(1)
    v_dot2c_f32_bf16_dpp v28, v26, v20 row_newbcast:3 row_mask:0xf bank_mask:0xf
    v_dot2c_f32_bf16_dpp v29, v27, v20 row_newbcast:3 row_mask:0xf bank_mask:0xf
    v_dot2c_f32_bf16_dpp v30, v26, v21 row_newbcast:7 row_mask:0xf bank_mask:0xf
    v_dot2c_f32_bf16_dpp v31, v27, v21 row_newbcast:7 row_mask:0xf bank_mask:0xf
    v_dot2c_f32_bf16_dpp v32, v26, v22 row_newbcast:11 row_mask:0xf bank_mask:0xf
    v_dot2c_f32_bf16_dpp v33, v27, v22 row_newbcast:11 row_mask:0xf bank_mask:0xf
    v_dot2c_f32_bf16_dpp v34, v26, v23 row_newbcast:15 row_mask:0xf bank_mask:0xf
    v_dot2c_f32_bf16_dpp v35, v27, v23 row_newbcast:15 row_mask:0xf bank_mask:0xf
    v_permlane32_swap_b32 v28, v32
    v_permlane32_swap_b32 v29, v33
    v_permlane32_swap_b32 v30, v34
    v_permlane32_swap_b32 v31, v35
    v_pk_add_f32 v[28:29], v[28:29], v[32:33]
    v_pk_add_f32 v[30:31], v[30:31], v[34:35]
    v_cmp_u_f32 vcc, v28, v30
    s_nop 0
    v_permlane16_swap_b32 v28, v30
    v_permlane16_swap_b32 v29, v31
    v_pk_add_f32 v[28:29], v[28:29], v[30:31]
    v_cvt_pk_bf16_f32 v28, v28, v29
    s_cbranch_vccnz L_retry_500070
L_got_500069:
    buffer_store_dword v28, v45, s[56:59], s12 offen sc1
    v_and_b32 v40, 4, v0
    v_lshlrev_b32 v40, 4, v40
    v_and_or_b32 v40, v0, 48, v40
    v_lshlrev_b32 v40, 1, v40
    v_and_or_b32 v40, v0, 11, v40
    v_lshl_add_u32 v40, v40, 3, s68
    ds_read_b64_tr_b16 v[48:49], v40 offset:4096
    ds_read_b64_tr_b16 v[50:51], v40 offset:4224
    ds_read_b64_tr_b16 v[52:53], v40 offset:6144
    ds_read_b64_tr_b16 v[54:55], v40 offset:6272
    ds_read_b64_tr_b16 v[56:57], v40 offset:4128
    ds_read_b64_tr_b16 v[58:59], v40 offset:4256
    ds_read_b64_tr_b16 v[60:61], v40 offset:6176
    ds_read_b64_tr_b16 v[62:63], v40 offset:6304
    v_lshrrev_b32 v41, 2, v0
    v_mul_u32_u24 v41, 1152, v41
    v_and_or_b32 v41, v6, 48, v41
    s_mov_b32 vcc_lo, 2290649224
    s_mov_b32 vcc_hi, 2290649224
    v_cndmask_b32 v41, v41, 2.0, vcc
    s_waitcnt lgkmcnt(0)
    s_barrier
    s_add_u32 m0, s68, 0
    s_add_u32 s83, s93, 0
    buffer_load_dwordx4 v41, s[44:47], s83 offen offset:0 lds
    s_add_u32 s83, s93, 17408
    buffer_load_dwordx4 v41, s[44:47], s83 offen offset:1024 lds
    s_add_u32 s83, s93, 34816
    buffer_load_dwordx4 v41, s[44:47], s83 offen offset:2048 lds
    s_add_u32 s83, s93, 52224
    buffer_load_dwordx4 v41, s[44:47], s83 offen offset:3072 lds
    s_add_u32 m0, s68, 4096
    s_add_u32 s83, s93, 73728
    buffer_load_dwordx4 v41, s[44:47], s83 offen offset:0 lds
    s_cmp_eq_u32 s71, 0
    s_cbranch_scc1 L_go_500071
    s_sleep 1
L_back_500072:
    v_lshrrev_b32 v28, 1, v0
    v_and_or_b32 v28, v28, 16, 0
    v_and_or_b32 v28, v0, 14, v28
    v_lshlrev_b32 v28, 6, v28
    v_and_or_b32 v28, v0, 16, v28
    v_lshlrev_b32 v28, 1, v28
    v_and_or_b32 v28, v6, 16, v28
    v_and_b32 v29, 56, v0
    v_lshlrev_b32 v29, 4, v29
    v_lshlrev_b32 v30, 3, v0
    v_and_b32 v30, 16, v30
    v_and_or_b32 v30, v0, 12, v30
    v_and_b32 v31, 32, v0
    v_lshl_or_b32 v30, v31, 3, v30
    s_mov_b32 vcc_lo, 4294945450
    s_mov_b32 vcc_hi, 4294945450
    v_cndmask_b32 v30, v30, 2.0, vcc
    s_lshl_b32 s79, s65, 10
    s_lshl_b32 s78, s66, 8
    s_add_u32 s79, s79, s78
    v_lshl_add_u32 v12, v0, 7, s79
    v_min_u32 v12, L_tailend-L_top_fast, v12
    s_getpc_b64 s[78:79]
L_pc_500074:
    s_add_u32 s78, s78, L_top_fast-L_pc_500074
    s_addc_u32 s79, s79, -1
    s_mov_b64 exec, 3
    global_load_dword v13, v12, s[78:79]
    s_mov_b64 exec, -1
    s_waitcnt lgkmcnt(0)
    s_sleep 1
    buffer_load_dword v16, v29, s[56:59], s15 offen sc1
    s_sleep 3
    buffer_load_dwordx4 v[8:11], v28, s[56:59], s14 offen sc1
    v_mov_b64 v[20:21], 0
    v_mov_b64 v[22:23], 0
    v_mov_b64 v[24:25], 0
    v_mov_b64 v[26:27], 0
    s_add_u32 m0, s68, 4096
    s_add_u32 s83, s93, 91136
    buffer_load_dwordx4 v41, s[44:47], s83 offen offset:1024 lds
    s_add_u32 s83, s93, 108544
    buffer_load_dwordx4 v41, s[44:47], s83 offen offset:2048 lds
    s_add_u32 s83, s93, 125952
    buffer_load_dwordx4 v41, s[44:47], s83 offen offset:3072 lds
    s_waitcnt vmcnt(4)
L_chk_500075:
    v_cmp_eq_u32 vcc, -1, v16
    v_max_f32_dpp v12, v16, v16 row_ror:8 row_mask:0xf bank_mask:0xf
    v_max_f32_dpp v17, v16, v16 row_ror:8 row_mask:0xf bank_mask:0xf
    s_nop 1
    v_permlane32_swap_b32 v17, v12
    v_max_f32 v14, v17, v12
    v_max_f32 v17, v17, v12
    s_cbranch_vccnz L_retry_500078
L_got_500077:
    s_nop 0
    v_permlane16_swap_b32 v17, v14
    v_max_f32 v17, v17, v14
    v_sub_f32 v16, v16, v17
    v_exp_f32 v16, v16
    s_nop 1
    v_add_f32_dpp v12, v16, v16 row_ror:8 row_mask:0xf bank_mask:0xf
    v_add_f32_dpp v17, v16, v16 row_ror:8 row_mask:0xf bank_mask:0xf
    s_nop 1
    v_permlane32_swap_b32 v17, v12
    v_add_f32 v14, v17, v12
    v_add_f32 v17, v17, v12
    s_nop 1
    v_permlane16_swap_b32 v17, v14
    v_add_f32 v17, v17, v14
    v_rcp_f32 v17, v17
    s_nop 1
    v_mul_f32_dpp v18, v16, v17 row_newbcast:0 row_mask:0xf bank_mask:0xf
    v_mul_f32_dpp v19, v16, v17 row_newbcast:8 row_mask:0xf bank_mask:0xf
    s_waitcnt vmcnt(3)
L_chk_500076:
    v_cmp_u_f32 vcc, v8, v8
    v_smfmac_f32_16x16x64_bf16 v[20:23], v[8:11], v[48:55], v1
    v_smfmac_f32_16x16x64_bf16 v[24:27], v[8:11], v[56:63], v1
    s_cbranch_vccnz L_retry_500080
L_got_500079:
    s_nop 5
    v_pk_mul_f32 v[20:21], v[20:21], v[18:19] op_sel_hi:[1,0]
    v_pk_fma_f32 v[20:21], v[22:23], v[18:19], v[20:21] op_sel:[0,1,0] op_sel_hi:[1,1,1]
    v_pk_mul_f32 v[24:25], v[24:25], v[18:19] op_sel_hi:[1,0]
    v_add_f32 v20, v20, v21
    v_pk_fma_f32 v[24:25], v[26:27], v[18:19], v[24:25] op_sel:[0,1,0] op_sel_hi:[1,1,1]
    v_add_f32 v24, v24, v25
    v_cmp_u_f32 vcc, v20, v20
    s_nop 0
    v_permlane32_swap_b32 v20, v24
    v_add_f32 v21, v20, v24
    v_add_f32 v20, v20, v24
    s_nop 1
    v_permlane16_swap_b32 v20, v21
    v_add_f32 v20, v20, v21
    s_cbranch_vccnz L_retry_500082
L_got_500081:
    s_nop 0
    v_mov_b32_dpp v21, v20 quad_perm:[1,0,3,2] row_mask:0xf bank_mask:0xf
    v_cvt_pk_bf16_f32 v20, v20, v21
    buffer_store_dword v20, v30, s[52:55], s16 offen sc1
    s_cmp_ge_u32 s65, 24
    s_cbranch_scc1 L_go_500083
    s_add_u32 s82, s21, 8192
    v_lshrrev_b32 v28, 4, v0
    v_bfe_u32 v29, v0, 2, 2
    v_lshl_add_u32 v28, v28, 3, v29
    v_mul_u32_u24 v28, 64, v28
    v_and_b32 v29, 3, v0
    v_lshl_add_u32 v28, v29, 3, v28
    v_add_u32 v28, s68, v28
    s_lshl_b32 s80, s66, 3
    s_add_u32 s80, s80, 146432
    s_waitcnt vmcnt(1)
    ds_read_b64_tr_b16 v[32:33], v28 offset:0
    ds_read_b64_tr_b16 v[34:35], v28 offset:256
    ds_read_b64_tr_b16 v[36:37], v28 offset:2048
    ds_read_b64_tr_b16 v[38:39], v28 offset:2304
    ds_read_b64_tr_b16 v[48:49], v28 offset:32
    ds_read_b64_tr_b16 v[50:51], v28 offset:288
    ds_read_b64_tr_b16 v[52:53], v28 offset:2080
    ds_read_b64_tr_b16 v[54:55], v28 offset:2336
    buffer_load_dwordx4 v[8:11], v6, s[52:55], s82 offen sc1
    buffer_load_dwordx4 v[12:15], v6, s[52:55], s82 offen offset:1024 sc1
    ds_read_b64_tr_b16 v[40:41], v28 offset:4096
    v_and_b32 v18, 15, v0
    ds_read_b64_tr_b16 v[42:43], v28 offset:4352
    v_lshrrev_b32 v19, 5, v0
    ds_read_b64_tr_b16 v[44:45], v28 offset:6144
    v_lshl_add_u32 v18, v19, 4, v18
    ds_read_b64_tr_b16 v[46:47], v28 offset:6400
    v_bfe_u32 v19, v0, 4, 1
    ds_read_b64_tr_b16 v[56:57], v28 offset:4128
    v_lshlrev_b32 v19, 2, v19
    ds_read_b64_tr_b16 v[58:59], v28 offset:4384
    v_lshl_add_u32 v18, v18, 5, v19
    ds_read_b64_tr_b16 v[60:61], v28 offset:6176
    v_add_u32 v18, s80, v18
    ds_read_b64_tr_b16 v[62:63], v28 offset:6432
    v_mov_b32 v19, 146432
    v_and_b32 v29, 15, v0
    v_lshl_add_u32 v19, v29, 6, v19
    v_lshlrev_b32 v29, 2, v0
    s_add_u32 s80, s96, 24576
    v_lshrrev_b32 v28, 4, v0
    v_lshlrev_b32 v17, 5, v28
    v_xor_b32 v17, v17, v6
    s_lshl_b32 s79, s66, 7
    v_xor_b32 v17, s79, v17
    v_and_b32 v17, 0xf0, v17
    v_lshl_or_b32 v17, v28, 13, v17
    s_waitcnt lgkmcnt(0)
    s_barrier
L_poll_500085:
    buffer_load_dwordx4 v[8:11], v6, s[52:55], s82 offen sc1
    buffer_load_dwordx4 v[12:15], v6, s[52:55], s82 offen offset:1024 sc1
    v_mov_b64 v[26:27], 0
    v_mov_b64 v[24:25], 0
    v_mov_b64 v[22:23], 0
    v_mov_b64 v[20:21], 0
    s_waitcnt vmcnt(2) lgkmcnt(0)
    v_cmp_u_f32 vcc, v8, v12
    v_smfmac_f32_16x16x64_bf16 v[20:23], v[8:11], v[32:39], v1
    v_smfmac_f32_16x16x64_bf16 v[20:23], v[12:15], v[40:47], v1
    s_cbranch_vccnz L_retry_500087
L_got_500086:
    v_smfmac_f32_16x16x64_bf16 v[24:27], v[8:11], v[48:55], v1
    v_smfmac_f32_16x16x64_bf16 v[24:27], v[12:15], v[56:63], v1
    s_nop 4
    v_pk_add_f32 v[20:21], v[20:21], v[22:23]
    v_add_f32 v20, v20, v21
    v_cmp_u_f32 vcc, v20, v20
    v_pk_add_f32 v[24:25], v[24:25], v[26:27]
    v_add_f32 v24, v24, v25
    s_nop 1
    v_permlane32_swap_b32 v20, v24
    v_add_f32 v20, v20, v24
    ds_write_b32 v18, v20
    s_cbranch_vccnz L_retry_500089
L_got_500088:
    s_bitcmp0_b32 s74, 0
    s_waitcnt vmcnt(0) lgkmcnt(0)
    s_barrier
    s_cbranch_scc1 L_noy_500090
    ds_read_b128 v[32:35], v19 offset:0
    ds_read_b128 v[36:39], v19 offset:16
    ds_read_b128 v[40:43], v19 offset:32
    ds_read_b128 v[44:47], v19 offset:48
    s_mov_b32 exec_hi, 0
    s_waitcnt lgkmcnt(2)
    v_pk_add_f32 v[32:33], v[32:33], v[34:35]
    v_pk_add_f32 v[36:37], v[36:37], v[38:39]
    v_pk_add_f32 v[32:33], v[32:33], v[36:37]
    v_add_f32 v32, v32, v33
    s_waitcnt lgkmcnt(0)
    v_pk_add_f32 v[40:41], v[40:41], v[42:43]
    v_pk_add_f32 v[44:45], v[44:45], v[46:47]
    v_pk_add_f32 v[40:41], v[40:41], v[44:45]
    v_add_f32 v33, v40, v41
    v_pk_add_f32 v[32:33], v[32:33], v[4:5]
    v_cvt_pk_bf16_f32 v34, v32, v33
    buffer_store_dword v34, v29, s[56:59], s80 offen sc1
    s_mov_b32 exec_hi, -1
L_noy_500090:
    s_cmp_eq_u32 s71, 1
    s_cbranch_scc1 L_final_slow
    s_add_u32 s52, s52, 73728
    s_addc_u32 s53, s53, 0
    s_mov_b32 s54, 57344
    s_mov_b32 s71, 1
    s_add_u32 m0, s68, 0
    s_add_u32 s79, s92, 0
    buffer_load_dwordx4 v17, s[24:27], s79 offen offset:0 nt lds
    s_add_u32 s79, s92, 31744
    buffer_load_dwordx4 v17, s[24:27], s79 offen offset:1024 nt lds
    s_add_u32 s79, s92, 63488
    buffer_load_dwordx4 v17, s[24:27], s79 offen offset:2048 nt lds
    s_add_u32 m0, s68, 3072
    s_add_u32 s79, s92, 98304
    buffer_load_dwordx4 v17, s[24:27], s79 offen offset:0 nt lds
    s_add_u32 s79, s92, 130048
    buffer_load_dwordx4 v17, s[24:27], s79 offen offset:1024 nt lds
    s_add_u32 s79, s92, 161792
    buffer_load_dwordx4 v17, s[24:27], s79 offen offset:2048 nt lds
    s_barrier
    s_cmp_eq_u32 s74, 3
    s_cselect_b64 vcc, -1, 0
    v_lshlrev_b32 v36, 16, v34
    v_and_b32 v37, 0xffff0000, v34
    v_pk_add_f32 v[32:33], v[32:33], v[36:37] neg_lo:[0,1] neg_hi:[0,1]
    v_cndmask_b32 v4, 0, v32, vcc
    v_cndmask_b32 v5, 0, v33, vcc
    v_mov_b32 v53, 0x3f803f80
    s_lshl_b64 s[82:83], s[84:85], 8
    v_cndmask_b32 v16, 0, v53, s[82:83]
    v_mov_b32 v17, v16
    v_mov_b64 v[18:19], v[16:17]
    v_mov_b64 v[20:21], v[16:17]
    v_mov_b64 v[22:23], v[16:17]
    v_mov_b64 v[24:25], v[16:17]
    v_mov_b64 v[26:27], v[16:17]
    v_lshrrev_b32 v12, 2, v0
    v_mul_u32_u24 v12, 3072, v12
    v_and_or_b32 v12, v6, 48, v12
    s_add_u32 s82, s86, 24576
    s_add_u32 s83, s68, 6144
    v_lshrrev_b32 v52, 4, v0
    v_bfe_u32 v53, v0, 2, 2
    v_lshl_add_u32 v52, v52, 5, v53
    v_and_b32 v53, 31, v0
    v_lshlrev_b32 v53, 3, v53
    v_lshl_or_b32 v52, v52, 8, v53
    s_lshl_b32 s78, s66, 6
    s_add_u32 s78, s78, 131072
    v_xor_b32 v52, s78, v52
    v_xor_b32 v54, 32, v52
    v_and_b32 v14, 31, v0
    v_lshlrev_b32 v14, 2, v14
    v_lshrrev_b32 v15, 1, v0
    s_mov_b32 vcc_lo, 0
    s_mov_b32 vcc_hi, 4294967295
    v_cndmask_b32 v14, v14, 2.0, vcc
    s_sub_u32 s78, s89, s87
    v_writelane_b32 v14, s78, 32
    s_add_u32 s78, s78, 4
    v_writelane_b32 v14, s78, 40
    s_mov_b64 s[22:23], 0x202
    v_and_b32 v11, 48, v0
    v_lshlrev_b32 v11, 3, v11
    v_and_or_b32 v11, v0, 7, v11
    v_lshlrev_b32 v11, 6, v11
    v_add_u32 v11, 137216, v11
    v_mov_b32 v13, 0
    s_sleep 6
    s_mov_b32 m0, s83
    s_mov_b64 exec, 0x77777777
    buffer_load_dword v13, v12, s[56:59], s82 offen sc1
    buffer_load_dwordx4 v12, s[56:59], s82 offen sc1 lds
    s_mov_b64 exec, -1
    v_lshlrev_b32 v60, 7, v0
    s_lshl_b32 s79, s64, 17
    s_lshl_b32 s78, s65, 12
    s_add_u32 s79, s79, s78
    s_lshl_b32 s78, s66, 10
    s_add_u32 s79, s79, s78
    s_mov_b32 exec_lo, 255
    s_mov_b32 exec_hi, 0
    buffer_load_dword v10, v60, s[48:51], s79 offen
    s_mov_b64 exec, -1
    s_waitcnt vmcnt(3)
    s_barrier
    ds_read_b64_tr_b16 v[28:29], v52 offset:0
    ds_read_b64_tr_b16 v[30:31], v52 offset:1024
    ds_read_b64_tr_b16 v[32:33], v54 offset:0
    ds_read_b64_tr_b16 v[34:35], v54 offset:1024
    ds_read_b64_tr_b16 v[36:37], v52 offset:2048
    ds_read_b64_tr_b16 v[38:39], v52 offset:3072
    ds_read_b64_tr_b16 v[40:41], v54 offset:2048
    ds_read_b64_tr_b16 v[42:43], v54 offset:3072
    ds_read_b64_tr_b16 v[44:45], v52 offset:4096
    ds_read_b64_tr_b16 v[46:47], v52 offset:5120
    ds_read_b64_tr_b16 v[48:49], v54 offset:4096
    ds_read_b64_tr_b16 v[50:51], v54 offset:5120
    s_waitcnt lgkmcnt(0)
    s_barrier
    s_waitcnt vmcnt(2)
L_chk_500091:
    v_cmp_eq_u32 vcc, -1, v13
    s_waitcnt vmcnt(1)
    s_cbranch_vccnz L_retry_500094
L_got_500093:
    s_mov_b64 exec, s[84:85]
    s_barrier
    ds_read_b128 v[16:19], v11 offset:0
    ds_read_b128 v[20:23], v11 offset:16
    ds_read_b128 v[24:27], v11 offset:32
    s_mov_b64 exec, -1
    s_waitcnt lgkmcnt(2)
    v_mfma_f32_16x16x32_bf16 v[60:63], v[16:19], v[16:19], 0
    s_waitcnt lgkmcnt(1)
    v_mfma_f32_16x16x32_bf16 v[60:63], v[20:23], v[20:23], v[60:63]
    s_waitcnt lgkmcnt(0)
    v_mfma_f32_16x16x32_bf16 v[60:63], v[24:27], v[24:27], v[60:63]
    v_mfma_f32_16x16x32_bf16 v[52:55], v[16:19], v[28:31], 0
    s_nop 1
    v_mfma_f32_16x16x32_bf16 v[52:55], v[20:23], v[36:39], v[52:55]
    s_nop 1
    v_mfma_f32_16x16x32_bf16 v[52:55], v[24:27], v[44:47], v[52:55]
    s_nop 0
    v_pk_add_f32 v[60:61], v[60:61], v[62:63]
    v_mfma_f32_16x16x32_bf16 v[56:59], v[16:19], v[32:35], 0
    v_add_f32 v62, v60, v61
    v_add_f32 v60, v60, v61
    v_mfma_f32_16x16x32_bf16 v[56:59], v[20:23], v[40:43], v[56:59]
    v_cmp_u_f32 vcc, v62, v62
    v_permlane16_swap_b32 v60, v62
    v_mfma_f32_16x16x32_bf16 v[56:59], v[24:27], v[48:51], v[56:59]
    v_add_f32 v60, v60, v62
    v_pk_add_f32 v[52:53], v[52:53], v[54:55]
    v_add_f32 v52, v52, v53
    v_add_f32_dpp v60, v60, v60 quad_perm:[1,0,3,2] row_mask:0xf bank_mask:0xf
    s_nop 1
    v_add_f32_dpp v60, v60, v60 quad_perm:[2,3,0,1] row_mask:0xf bank_mask:0xf
    s_nop 0
    v_pk_add_f32 v[56:57], v[56:57], v[58:59]
    v_add_f32 v56, v56, v57
    v_add_f32_dpp v60, v60, v60 row_half_mirror row_mask:0xf bank_mask:0xf
    s_cbranch_vccnz L_retry_500097
L_got_500096:
    v_permlane16_swap_b32 v52, v56
    v_add_f32 v52, v52, v56
    s_nop 1
    v_permlane32_swap_b32 v52, v60
    buffer_store_dword v52, v14, s[52:55], s87 offen sc1
L_back_500084:
    v_and_b32 v44, 4, v0
    v_lshlrev_b32 v44, 3, v44
    v_and_b32 v45, 3, v0
    v_lshl_or_b32 v44, v45, 2, v44
    v_lshrrev_b32 v45, 5, v0
    v_lshl_or_b32 v44, v45, 4, v44
    v_bfe_u32 v45, v0, 4, 1
    v_lshl_or_b32 v44, v45, 1, v44
    s_lshl_b32 s78, s66, 6
    s_add_u32 s78, s78, 154624
    v_add_u32 v44, s78, v44
    v_and_b32 v45, 7, v0
    v_lshlrev_b32 v45, 3, v45
    s_mov_b32 vcc_lo, 3233857728
    s_mov_b32 vcc_hi, 3233857728
    v_cndmask_b32 v45, v45, 2.0, vcc
    s_mov_b32 vcc_lo, 0
    s_mov_b32 vcc_hi, 4294901760
    v_cndmask_b32 v47, v6, 2.0, vcc
    v_and_b32 v46, 48, v0
    v_lshlrev_b32 v46, 1, v46
    v_and_or_b32 v46, v6, 16, v46
    v_add_u32 v46, 154624, v46
    s_sleep 1
    buffer_load_dwordx2 v[12:13], v45, s[52:55], s91 offen sc1
    buffer_load_dwordx4 v[8:11], v47, s[52:55], s90 offen sc1
    v_mov_b64 v[20:21], 0
    v_lshl_add_u32 v17, v0, 3, s68
    ds_write_b64 v17, v[20:21] offset:6656
    s_add_u32 s78, s68, 6656
    v_mov_b32 v17, s78
    s_mov_b32 s22, 196611
    s_mov_b32 s23, 196611
    v_cndmask_b32 v56, v17, v46, s[22:23]
    s_lshl_b64 s[22:23], s[22:23], 4
    v_cndmask_b32 v57, v17, v46, s[22:23]
    s_lshl_b64 s[22:23], s[22:23], 4
    v_cndmask_b32 v58, v17, v46, s[22:23]
    s_lshl_b64 s[22:23], s[22:23], 4
    v_cndmask_b32 v59, v17, v46, s[22:23]
    s_lshl_b64 s[22:23], s[22:23], 4
    v_and_b32 v60, 0x32, v0
    v_lshlrev_b32 v60, 3, v60
    v_and_b32 v17, 8, v0
    v_lshl_or_b32 v60, v17, 2, v60
    v_and_b32 v17, 5, v0
    v_lshl_or_b32 v60, v17, 1, v60
    v_add_u32 v60, s68, v60
    v_add_u32 v61, 0, v0
    v_mul_u32_u24 v17, 21846, v61
    v_lshrrev_b32 v17, 16, v17
    v_mul_u32_u24 v17, 1104, v17
    v_lshl_add_u32 v61, v0, 4, v17
    v_add_u32 v62, 64, v0
    v_mul_u32_u24 v17, 21846, v62
    v_lshrrev_b32 v17, 16, v17
    v_mul_u32_u24 v17, 1104, v17
    v_lshl_add_u32 v62, v0, 4, v17
    v_add_u32 v63, 128, v0
    v_mul_u32_u24 v17, 21846, v63
    v_lshrrev_b32 v17, 16, v17
    v_mul_u32_u24 v17, 1104, v17
    v_lshl_add_u32 v63, v0, 4, v17
    s_add_u32 s83, s93, 73728
    v_mov_b64 v[16:17], 0
    v_mov_b64 v[24:25], 0
    v_mov_b64 v[28:29], 0
    v_mov_b32 v39, 0x4575fdf0
L_poll_500099:
    buffer_load_dwordx2 v[12:13], v45, s[52:55], s91 offen sc1
    buffer_load_dwordx4 v[8:11], v47, s[52:55], s90 offen sc1
    s_waitcnt vmcnt(2)
    v_max_u32 v38, v8, v12
    v_cmp_eq_u32 vcc, -1, v38
    v_mov_b64 v[36:37], v[12:13]
    v_mov_b64 v[32:33], v[8:9]
    v_mov_b64 v[34:35], v[10:11]
    s_cbranch_vccnz L_retry_500103
L_got_500102:
    v_add_f32_dpp v37, v37, v37 row_ror:4 row_mask:0xf bank_mask:0xf
    v_permlane32_swap_b32 v32, v34
    v_add_f32_dpp v36, v36, v36 row_ror:4 row_mask:0xf bank_mask:0xf
    v_permlane32_swap_b32 v33, v35
    v_add_f32_dpp v37, v37, v37 row_ror:2 row_mask:0xf bank_mask:0xf
    v_pk_add_f32 v[32:33], v[32:33], v[34:35]
    v_add_f32_dpp v36, v36, v36 row_ror:2 row_mask:0xf bank_mask:0xf
    s_nop 0
    v_permlane16_swap_b32 v32, v33
    v_add_f32_dpp v37, v37, v37 row_ror:1 row_mask:0xf bank_mask:0xf
    v_add_f32 v32, v32, v33
    v_add_f32_dpp v36, v36, v36 row_ror:1 row_mask:0xf bank_mask:0xf
    s_nop 0
    v_add_f32_dpp v32, v32, v32 row_ror:8 row_mask:0xf bank_mask:0xf
    v_mul_f32 v37, 0x37e38e39, v37
    v_and_b32 v33, 0xffff0000, v1
    v_mul_f32 v36, 0x37e38e39, v36
    v_fma_f32 v36, -v37, v37, v36
    v_max_f32 v36, 0, v36
    v_fmaak_f32 v36, v39, v36, 0x3a21369a
    v_rsq_f32 v36, v36
    v_fma_f32 v32, -v37, v33, v32
    v_mul_f32 v32, v32, v36
    v_cvt_pk_bf16_f32 v32, v32, v32
    ds_write_b16 v44, v32
    v_lshlrev_b32 v33, 16, v32
    v_cmp_u_f32 vcc, v33, v33
    s_sub_u32 s80, s68, 148480
    s_cmp_eq_u32 s66, 0
    s_cselect_b32 s81, s18, 1073741824
    s_mov_b32 s22, 196611
    s_mov_b32 s23, 196611
    s_cbranch_vccnz L_retry_500105
L_got_500104:
    s_waitcnt vmcnt(0) lgkmcnt(0)
    s_barrier
    ds_read_b128 v[32:35], v56 offset:0
    ds_read_b128 v[36:39], v56 offset:128
    ds_read_b128 v[40:43], v57 offset:0
    ds_read_b128 v[44:47], v57 offset:128
    ds_read_b128 v[48:51], v58 offset:0
    ds_read_b128 v[52:55], v58 offset:128
    v_mov_b32 v14, v2
    s_waitcnt lgkmcnt(5)
    v_smfmac_f32_16x16x64_bf16 v[16:19], v[32:35], a[0:7], v1
    s_add_u32 m0, s68, 0
    s_waitcnt lgkmcnt(4)
    v_smfmac_f32_16x16x64_bf16 v[16:19], v[36:39], a[8:15], v1
    ds_read_b64_tr_b16 a[0:1], v14 offset:0
    buffer_load_dwordx4 v61, s[28:31], s93 offen offset:0 lds
    v_smfmac_f32_16x16x64_bf16 v[20:23], v[32:35], a[16:23], v1
    ds_read_b64_tr_b16 a[2:3], v14 offset:4096
    v_smfmac_f32_16x16x64_bf16 v[20:23], v[36:39], a[24:31], v1
    ds_read_b64_tr_b16 a[4:5], v14 offset:8192
    v_smfmac_f32_16x16x64_bf16 v[24:27], v[32:35], a[32:39], v1
    ds_read_b64_tr_b16 a[6:7], v14 offset:12288
    v_xor_b32 v15, 32, v2
    v_smfmac_f32_16x16x64_bf16 v[24:27], v[36:39], a[40:47], v1
    ds_read_b64_tr_b16 a[8:9], v15 offset:0
    v_mov_b64 v[8:9], 0
    v_smfmac_f32_16x16x64_bf16 v[28:31], v[32:35], a[48:55], v1
    ds_read_b64_tr_b16 a[10:11], v15 offset:4096
    v_mov_b64 v[12:13], 0
    s_add_u32 m0, s68, 0
    v_smfmac_f32_16x16x64_bf16 v[28:31], v[36:39], a[56:63], v1
    ds_read_b64_tr_b16 a[12:13], v15 offset:8192
    buffer_load_dwordx4 v62, s[28:31], s93 offen offset:1024 lds
    s_waitcnt lgkmcnt(7)
    v_smfmac_f32_16x16x64_bf16 v[16:19], v[40:43], a[64:71], v1
    ds_read_b128 v[32:35], v59 offset:0
    v_mov_b32 v10, s80
    v_smfmac_f32_16x16x64_bf16 v[16:19], v[44:47], a[72:79], v1
    ds_read_b128 v[36:39], v59 offset:128
    v_smfmac_f32_16x16x64_bf16 v[20:23], v[40:43], a[80:87], v1
    ds_read_b64_tr_b16 a[14:15], v15 offset:12288
    v_xor_b32 v14, 64, v2
    v_smfmac_f32_16x16x64_bf16 v[20:23], v[44:47], a[88:95], v1
    ds_read_b64_tr_b16 a[16:17], v14 offset:0
    v_smfmac_f32_16x16x64_bf16 v[24:27], v[40:43], a[96:103], v1
    ds_read_b64_tr_b16 a[18:19], v14 offset:4096
    s_add_u32 m0, s68, 0
    v_smfmac_f32_16x16x64_bf16 v[24:27], v[44:47], a[104:111], v1
    ds_read_b64_tr_b16 a[20:21], v14 offset:8192
    buffer_load_dwordx4 v63, s[28:31], s93 offen offset:2048 lds
    v_smfmac_f32_16x16x64_bf16 v[28:31], v[40:43], a[112:119], v1
    ds_read_b64_tr_b16 a[22:23], v14 offset:12288
    v_xor_b32 v15, 96, v2
    v_smfmac_f32_16x16x64_bf16 v[28:31], v[44:47], a[120:127], v1
    ds_read_b64_tr_b16 a[24:25], v15 offset:0
    v_smfmac_f32_16x16x64_bf16 v[16:19], v[48:51], a[128:135], v1
    ds_read_b64_tr_b16 a[26:27], v15 offset:4096
    v_smfmac_f32_16x16x64_bf16 v[16:19], v[52:55], a[136:143], v1
    ds_read_b64_tr_b16 a[28:29], v15 offset:8192
    v_smfmac_f32_16x16x64_bf16 v[20:23], v[48:51], a[144:151], v1
    ds_read_b64_tr_b16 a[30:31], v15 offset:12288
    s_add_u32 m0, s68, 3072
    v_xor_b32 v14, 128, v2
    v_smfmac_f32_16x16x64_bf16 v[20:23], v[52:55], a[152:159], v1
    ds_read_b64_tr_b16 a[32:33], v14 offset:0
    buffer_load_dwordx4 v61, s[28:31], s83 offen offset:0 lds
    v_smfmac_f32_16x16x64_bf16 v[24:27], v[48:51], a[160:167], v1
    ds_read_b64_tr_b16 a[34:35], v14 offset:4096
    v_smfmac_f32_16x16x64_bf16 v[24:27], v[52:55], a[168:175], v1
    ds_read_b64_tr_b16 a[36:37], v14 offset:8192
    v_smfmac_f32_16x16x64_bf16 v[28:31], v[48:51], a[176:183], v1
    ds_read_b64_tr_b16 a[38:39], v14 offset:12288
    v_xor_b32 v15, 160, v2
    v_smfmac_f32_16x16x64_bf16 v[28:31], v[52:55], a[184:191], v1
    ds_read_b64_tr_b16 a[40:41], v15 offset:0
    s_waitcnt lgkmcnt(14)
    v_smfmac_f32_16x16x64_bf16 v[16:19], v[32:35], a[192:199], v1
    ds_read_b64_tr_b16 a[42:43], v15 offset:4096
    s_add_u32 m0, s68, 3072
    v_smfmac_f32_16x16x64_bf16 v[16:19], v[36:39], a[200:207], v1
    ds_read_b64_tr_b16 a[44:45], v15 offset:8192
    buffer_load_dwordx4 v62, s[28:31], s83 offen offset:1024 lds
    v_smfmac_f32_16x16x64_bf16 v[20:23], v[32:35], a[208:215], v1
    ds_read_b64_tr_b16 a[46:47], v15 offset:12288
    v_xor_b32 v14, 192, v2
    v_smfmac_f32_16x16x64_bf16 v[20:23], v[36:39], a[216:223], v1
    ds_read_b64_tr_b16 a[48:49], v14 offset:0
    v_smfmac_f32_16x16x64_bf16 v[24:27], v[32:35], a[224:231], v1
    ds_read_b64_tr_b16 a[50:51], v14 offset:4096
    v_smfmac_f32_16x16x64_bf16 v[24:27], v[36:39], a[232:239], v1
    ds_read_b64_tr_b16 a[52:53], v14 offset:8192
    v_smfmac_f32_16x16x64_bf16 v[28:31], v[32:35], a[240:247], v1
    ds_read_b64_tr_b16 a[54:55], v14 offset:12288
    s_add_u32 m0, s68, 3072
    v_xor_b32 v15, 224, v2
    v_smfmac_f32_16x16x64_bf16 v[28:31], v[36:39], a[248:255], v1
    ds_read_b64_tr_b16 a[56:57], v15 offset:0
    buffer_load_dwordx4 v63, s[28:31], s83 offen offset:2048 lds
    ds_read_b64_tr_b16 a[58:59], v15 offset:4096
    v_add_f32 v16, v16, v17
    ds_read_b64_tr_b16 a[60:61], v15 offset:8192
    v_add_f32 v17, v20, v21
    ds_read_b64_tr_b16 a[62:63], v15 offset:12288
    v_add_f32 v18, v24, v25
    v_add_f32 v19, v28, v29
    v_max3_f32 v20, v16, v17, v18
    v_max_f32 v20, v20, v19
    v_cndmask_b32 v11, 0, v10, s[22:23]
    v_add_u32 v56, v56, v11
    v_max_f32_dpp v20, v20, v20 row_ror:8 row_mask:0xf bank_mask:0xf
    s_lshl_b64 s[22:23], s[22:23], 4
    v_cndmask_b32 v11, 0, v10, s[22:23]
    v_max_f32_dpp v20, v20, v20 row_ror:4 row_mask:0xf bank_mask:0xf
    v_add_u32 v57, v57, v11
    s_lshl_b64 s[22:23], s[22:23], 4
    v_max_f32_dpp v20, v20, v20 row_ror:2 row_mask:0xf bank_mask:0xf
    v_cndmask_b32 v11, 0, v10, s[22:23]
    v_add_u32 v58, v58, v11
    v_max_f32_dpp v20, v20, v20 row_ror:1 row_mask:0xf bank_mask:0xf
    s_lshl_b64 s[22:23], s[22:23], 4
    v_cndmask_b32 v11, 0, v10, s[22:23]
    v_max_f32_dpp v20, v20, v20 row_bcast:15 row_mask:0xa bank_mask:0xf
    v_add_u32 v59, v59, v11
    s_nop 0
    v_max_f32_dpp v20, v20, v20 row_bcast:31 row_mask:0xc bank_mask:0xf
    s_nop 0
    v_readlane_b32 s73, v20, 63
    s_nop 1
    v_subrev_f32 v16, s73, v16
    v_subrev_f32 v17, s73, v17
    v_subrev_f32 v18, s73, v18
    v_subrev_f32 v19, s73, v19
    v_exp_f32 v16, v16
    v_exp_f32 v17, v17
    v_exp_f32 v18, v18
    v_exp_f32 v19, v19
    v_cvt_pk_bf16_f32 v22, v16, v17
    v_cvt_pk_bf16_f32 v23, v18, v19
    ds_write_b16 v60, v22 offset:6144
    ds_write_b16_d16_hi v60, v22 offset:6148
    ds_write_b16 v60, v23 offset:6208
    ds_write_b16_d16_hi v60, v23 offset:6212
    ds_read_b128 v[32:35], v56 offset:0
    ds_read_b128 v[36:39], v56 offset:128
    ds_read_b128 v[40:43], v56 offset:256
    ds_read_b128 v[44:47], v56 offset:384
    v_pk_add_f32 v[16:17], v[16:17], v[18:19]
    v_add_f32 v21, v16, v17
    s_lshl_b32 s78, s66, 3
    s_add_u32 s78, s78, 138240
    v_add_f32_dpp v21, v21, v21 row_ror:8 row_mask:0xf bank_mask:0xf
    v_mov_b32 v22, 0x30000
    v_mov_b32 v20, s73
    v_add_f32_dpp v21, v21, v21 row_ror:4 row_mask:0xf bank_mask:0xf
    s_mov_b32 s23, 138240
    s_waitcnt lgkmcnt(3)
    v_smfmac_f32_16x16x64_bf16 v[8:11], v[32:35], v[64:71], v1
    v_add_f32_dpp v21, v21, v21 row_ror:2 row_mask:0xf bank_mask:0xf
    v_smfmac_f32_16x16x64_bf16 v[12:15], v[32:35], v[96:103], v1
    ds_read_b128 v[48:51], v57 offset:0
    v_add_f32_dpp v21, v21, v21 row_ror:1 row_mask:0xf bank_mask:0xf
    s_waitcnt lgkmcnt(3)
    v_smfmac_f32_16x16x64_bf16 v[8:11], v[36:39], v[128:135], v1
    v_add_f32_dpp v21, v21, v21 row_bcast:15 row_mask:0xa bank_mask:0xf
    v_smfmac_f32_16x16x64_bf16 v[12:15], v[36:39], v[160:167], v1
    ds_read_b128 v[52:55], v57 offset:128
    v_add_f32_dpp v21, v21, v21 row_bcast:31 row_mask:0xc bank_mask:0xf
    s_waitcnt lgkmcnt(2)
    v_smfmac_f32_16x16x64_bf16 v[8:11], v[40:43], v[192:199], v1
    v_writelane_b32 v22, s78, 63
    ds_write_b64 v22, v[20:21]
    v_smfmac_f32_16x16x64_bf16 v[12:15], v[40:43], v[224:231], v1
    ds_read_b128 v[32:35], v57 offset:256
    v_smfmac_f32_16x16x64_bf16 v[8:11], v[44:47], a[0:7], v1
    v_and_b32 v23, 3, v0
    v_smfmac_f32_16x16x64_bf16 v[12:15], v[44:47], a[32:39], v1
    ds_read_b128 v[36:39], v57 offset:384
    s_waitcnt lgkmcnt(3)
    v_smfmac_f32_16x16x64_bf16 v[8:11], v[48:51], v[72:79], v1
    s_waitcnt lgkmcnt(2)
    s_barrier
    v_smfmac_f32_16x16x64_bf16 v[12:15], v[48:51], v[104:111], v1
    ds_read_b128 v[40:43], v58 offset:0
    v_lshl_add_u32 v23, v23, 3, s23
    ds_read_b64 v[24:25], v23
    v_smfmac_f32_16x16x64_bf16 v[8:11], v[52:55], v[136:143], v1
    v_smfmac_f32_16x16x64_bf16 v[12:15], v[52:55], v[168:175], v1
    ds_read_b128 v[44:47], v58 offset:128
    s_waitcnt lgkmcnt(3)
    v_smfmac_f32_16x16x64_bf16 v[8:11], v[32:35], v[200:207], v1
    v_smfmac_f32_16x16x64_bf16 v[12:15], v[32:35], v[232:239], v1
    ds_read_b128 v[48:51], v58 offset:256
    s_waitcnt lgkmcnt(2)
    v_smfmac_f32_16x16x64_bf16 v[8:11], v[36:39], a[8:15], v1
    v_max_f32_dpp v22, v24, v24 quad_perm:[1,0,3,2] row_mask:0xf bank_mask:0xf
    v_smfmac_f32_16x16x64_bf16 v[12:15], v[36:39], a[40:47], v1
    ds_read_b128 v[52:55], v58 offset:384
    v_max_f32_dpp v22, v22, v22 quad_perm:[2,3,0,1] row_mask:0xf bank_mask:0xf
    s_waitcnt lgkmcnt(2)
    v_smfmac_f32_16x16x64_bf16 v[8:11], v[40:43], v[80:87], v1
    v_sub_f32 v24, v24, v22
    v_smfmac_f32_16x16x64_bf16 v[12:15], v[40:43], v[112:119], v1
    ds_read_b128 v[32:35], v59 offset:0
    v_exp_f32 v24, v24
    v_smfmac_f32_16x16x64_bf16 v[8:11], v[44:47], v[144:151], v1
    v_mul_f32 v19, v24, v25
    v_smfmac_f32_16x16x64_bf16 v[12:15], v[44:47], v[176:183], v1
    ds_read_b128 v[36:39], v59 offset:128
    s_waitcnt lgkmcnt(2)
    v_smfmac_f32_16x16x64_bf16 v[8:11], v[48:51], v[208:215], v1
    v_add_f32_dpp v19, v19, v19 quad_perm:[1,0,3,2] row_mask:0xf bank_mask:0xf
    v_smfmac_f32_16x16x64_bf16 v[12:15], v[48:51], v[240:247], v1
    ds_read_b128 v[40:43], v59 offset:256
    v_smfmac_f32_16x16x64_bf16 v[8:11], v[52:55], a[16:23], v1
    v_add_f32_dpp v19, v19, v19 quad_perm:[2,3,0,1] row_mask:0xf bank_mask:0xf
    v_smfmac_f32_16x16x64_bf16 v[12:15], v[52:55], a[48:55], v1
    ds_read_b128 v[44:47], v59 offset:384
    v_log_f32 v25, v19
    s_waitcnt lgkmcnt(2)
    v_smfmac_f32_16x16x64_bf16 v[8:11], v[32:35], v[88:95], v1
    v_add_f32 v25, v25, v22
    v_smfmac_f32_16x16x64_bf16 v[12:15], v[32:35], v[120:127], v1
    buffer_store_dword v25, off, s[52:55], s81 sc1
    v_smfmac_f32_16x16x64_bf16 v[8:11], v[36:39], v[152:159], v1
    v_sub_f32 v18, s73, v25
    v_smfmac_f32_16x16x64_bf16 v[12:15], v[36:39], v[184:191], v1
    v_exp_f32 v18, v18
    s_waitcnt lgkmcnt(0)
    v_smfmac_f32_16x16x64_bf16 v[8:11], v[40:43], v[216:223], v1
    v_lshrrev_b32 v23, 4, v0
    v_smfmac_f32_16x16x64_bf16 v[12:15], v[40:43], v[248:255], v1
    v_lshl_add_u32 v23, v23, 1, v0
    v_smfmac_f32_16x16x64_bf16 v[8:11], v[44:47], a[24:31], v1
    v_and_b32 v23, 7, v23
    v_smfmac_f32_16x16x64_bf16 v[12:15], v[44:47], a[56:63], v1
    v_lshl_add_u32 v46, v0, 2, s68
    v_lshlrev_b32 v47, 2, v23
    s_nop 3
    v_add_f32 v44, v8, v9
    s_nop 0
    v_add_f32 v45, v12, v13
    v_pk_mul_f32 v[44:45], v[44:45], v[18:19] op_sel_hi:[1,0]
    s_branch L_top_slow
L_final_slow:
    s_cmp_lg_u32 s74, 3
    s_cbranch_scc1 L_fin2
    s_cmp_eq_u32 s74, 3
    s_cselect_b64 vcc, -1, 0
    v_lshlrev_b32 v36, 16, v34
    v_and_b32 v37, 0xffff0000, v34
    v_pk_add_f32 v[32:33], v[32:33], v[36:37] neg_lo:[0,1] neg_hi:[0,1]
    v_cndmask_b32 v4, 0, v32, vcc
    v_cndmask_b32 v5, 0, v33, vcc
    v_lshrrev_b32 v8, 4, v0
    v_mul_u32_u24 v8, 768, v8
    v_and_or_b32 v8, v0, 15, v8
    v_lshlrev_b32 v8, 2, v8
    s_mov_b32 vcc_lo, 4026593280
    s_mov_b32 vcc_hi, 4026593280
    v_cndmask_b32 v8, v8, 2.0, vcc
    s_mov_b64 vcc, 0xfff
    v_cndmask_b32 v4, 0, v4, vcc
    v_cndmask_b32 v5, 0, v5, vcc
    v_and_b32 v9, 15, v0
    v_lshrrev_b32 v10, 5, v0
    v_lshl_or_b32 v9, v9, 1, v10
    v_lshlrev_b32 v9, 1, v9
    s_mov_b32 vcc_lo, 4294963200
    s_mov_b32 vcc_hi, 4294963200
    v_cndmask_b32 v9, v9, 2.0, vcc
    v_mov_b32 v12, 0x3f80
    v_mov_b32 v13, 0x3f800000
    s_add_u32 s80, s20, 24576
    s_add_u32 s81, s80, 12288
    s_mul_i32 s78, s65, 48
    s_sleep 6
    buffer_load_dword v10, v8, s[56:59], s80 offen sc1
    buffer_load_dword v11, v8, s[56:59], s81 offen sc1
    v_mov_b64 v[14:15], v[4:5]
    s_waitcnt vmcnt(0)
L_chk_500106:
    v_cmp_u_f32 vcc, v10, v11
    v_dot2c_f32_bf16 v14, v12, v10
    v_dot2c_f32_bf16 v15, v13, v10
    v_dot2c_f32_bf16 v14, v12, v11
    v_dot2c_f32_bf16 v15, v13, v11
    s_cbranch_vccnz L_retry_500108
L_got_500107:
    s_nop 1
    v_permlane32_swap_b32 v14, v15
    v_add_f32 v16, v14, v15
    v_add_f32 v14, v14, v15
    s_nop 1
    v_permlane16_swap_b32 v14, v16
    v_add_f32 v14, v14, v16
    v_cvt_pk_bf16_f32 v14, v14, v14
    buffer_store_short v14, v9, s[60:63], s78 offen
    s_branch L_fin2
L_res_500002:
    s_nop 1
    v_lshlrev_b32 v8, 2, v0
    s_add_u32 s80, s20, 24576
    s_mov_b64 exec, 0xfff
L_poll_501004:
    s_add_u32 s81, s80, 0
    buffer_load_dword v20, v8, s[56:59], s81 offen offset:0 sc1
    buffer_load_dword v21, v8, s[56:59], s81 offen offset:3072 sc1
    s_add_u32 s81, s80, 6144
    buffer_load_dword v22, v8, s[56:59], s81 offen offset:0 sc1
    buffer_load_dword v23, v8, s[56:59], s81 offen offset:3072 sc1
    s_add_u32 s81, s80, 12288
    buffer_load_dword v24, v8, s[56:59], s81 offen offset:0 sc1
    s_branch L_resp_500004
L_resp_500004:
    buffer_load_dword v25, v8, s[56:59], s81 offen offset:3072 sc1
    s_add_u32 s81, s80, 18432
    buffer_load_dword v26, v8, s[56:59], s81 offen offset:0 sc1
    buffer_load_dword v27, v8, s[56:59], s81 offen offset:3072 sc1
    v_mov_b32 v28, 0x3f80
    v_mov_b32 v29, 0x3f800000
    v_mov_b64 v[30:31], v[4:5]
    s_waitcnt vmcnt(6)
    v_dot2c_f32_bf16 v30, v28, v20
    v_dot2c_f32_bf16 v31, v29, v20
    v_dot2c_f32_bf16 v30, v28, v21
    v_dot2c_f32_bf16 v31, v29, v21
    s_waitcnt vmcnt(4)
    v_dot2c_f32_bf16 v30, v28, v22
    s_branch L_resp_500005
L_resp_500005:
    v_dot2c_f32_bf16 v31, v29, v22
    v_dot2c_f32_bf16 v30, v28, v23
    v_dot2c_f32_bf16 v31, v29, v23
    s_waitcnt vmcnt(2)
    v_dot2c_f32_bf16 v30, v28, v24
    v_dot2c_f32_bf16 v31, v29, v24
    v_dot2c_f32_bf16 v30, v28, v25
    v_dot2c_f32_bf16 v31, v29, v25
    s_waitcnt vmcnt(0)
    v_dot2c_f32_bf16 v30, v28, v26
    v_dot2c_f32_bf16 v31, v29, v26
    v_dot2c_f32_bf16 v30, v28, v27
    v_dot2c_f32_bf16 v31, v29, v27
    s_nop 2
    s_branch L_resp_500006
L_resp_500006:
    v_cmp_u_f32 vcc, v30, v31
    s_cbranch_vccnz L_retry_501008
L_got_501007:
    v_mov_b64 v[4:5], v[30:31]
    s_mov_b64 exec, -1
    s_branch L_resback_500003
L_retry_501008:
    s_cselect_b32 s3, 1, 0
    s_add_u32 s72, s72, 1
    s_cmp_gt_u32 s72, 200000
    s_cbranch_scc0 L_poll_501004
    s_cmp_eq_u32 s3, 1
    s_branch L_got_501007
L_retry_500012:
    s_cmp_gt_u32 s72, 200000
    s_cbranch_scc1 L_got_500011
    buffer_load_dword v16, v47, s[52:55], s19 offen sc1
    s_add_u32 s72, s72, 1
    s_waitcnt vmcnt(1)
    s_branch L_chk_500009
L_retry_500015:
    s_cselect_b32 s3, 1, 0
    s_add_u32 s72, s72, 1
    s_cmp_gt_u32 s72, 200000
    s_nop 1
    s_cbranch_scc0 L_poll_500013
    s_cmp_eq_u32 s3, 1
    s_branch L_got_500014
L_retry_500017:
    s_cselect_b32 s3, 1, 0
    s_add_u32 s72, s72, 1
    s_cmp_gt_u32 s72, 200000
    s_nop 1
    s_cbranch_scc0 L_poll_500013
    s_cmp_eq_u32 s3, 1
    s_branch L_got_500016
L_go_500019:
    s_nop 1
    v_mov_b32 v56, -1
    v_mov_b32 v57, -1
    v_mov_b32 v58, -1
    v_mov_b32 v59, -1
    s_mul_i32 s79, s64, 49152
    s_mul_i32 s78, s65, 1536
    s_add_u32 s79, s79, s78
    s_mul_i32 s78, s66, 384
    s_add_u32 s79, s79, s78
    s_add_u32 s79, s79, 1441792
    s_mov_b64 exec, 16777215
    buffer_store_dwordx4 v[56:59], v6, s[48:51], s79 offen sc1
    s_branch L_p_500021
L_p_500021:
    s_mov_b64 exec, -1
    s_sleep 10
    s_nop 1
    s_branch L_back_500020
L_retry_500026:
    s_cmp_gt_u32 s72, 200000
    s_cbranch_scc1 L_got_500025
    s_mov_b32 m0, s83
    s_mov_b64 exec, 0x77777777
    buffer_load_dword v13, v12, s[56:59], s82 offen sc1
    buffer_load_dwordx4 v12, s[56:59], s82 offen sc1 lds
    s_mov_b64 exec, -1
    s_add_u32 s72, s72, 1
    s_waitcnt vmcnt(0)
    s_branch L_chk_500023
L_retry_500029:
    s_cselect_b32 s3, 1, 0
    s_add_u32 s72, s72, 1
    s_cmp_gt_u32 s72, 200000
    s_nop 1
    s_cbranch_scc0 L_again_500027
    s_cmp_eq_u32 s3, 1
    s_branch L_got_500028
L_again_500027:
    s_barrier
    s_branch L_retry_500026
L_go_500007:
    s_nop 1
    v_lshrrev_b32 v9, 4, v0
    v_lshlrev_b32 v8, 5, v9
    v_xor_b32 v8, v8, v6
    v_and_b32 v8, 0xf0, v8
    v_lshl_or_b32 v8, v9, 13, v8
    s_mov_b32 m0, s68
    s_add_u32 s79, s94, 0
    buffer_load_dwordx4 v8, s[36:39], s79 offen offset:0  lds
    s_add_u32 s79, s94, 31744
    v_xor_b32 v9, 128, v8
    buffer_load_dwordx4 v9, s[36:39], s79 offen offset:1024  lds
    s_add_u32 s79, s94, 63488
    s_branch L_p_500030
L_p_500030:
    v_xor_b32 v9, 144, v8
    buffer_load_dwordx4 v9, s[36:39], s79 offen offset:2048  lds
    s_add_u32 s79, s94, 95232
    v_xor_b32 v9, 16, v8
    buffer_load_dwordx4 v9, s[36:39], s79 offen offset:3072  lds
    v_lshlrev_b32 v60, 7, v0
    s_lshl_b32 s79, s64, 17
    s_lshl_b32 s78, s65, 12
    s_add_u32 s79, s79, s78
    s_lshl_b32 s78, s66, 10
    s_add_u32 s79, s79, s78
    s_mov_b32 exec_lo, 255
    s_mov_b32 exec_hi, 0
    buffer_load_dword v10, v60, s[48:51], s79 offen
    s_branch L_p_500031
L_p_500031:
    s_mov_b64 exec, -1
    s_lshl_b32 s79, s65, 10
    s_lshl_b32 s78, s66, 8
    s_add_u32 s79, s79, s78
    v_lshl_add_u32 v60, v0, 7, s79
    v_min_u32 v60, L_tailend-L_top_fast, v60
    s_getpc_b64 s[78:79]
L_pc_514030:
    s_add_u32 s78, s78, L_top_fast-L_pc_514030
    s_addc_u32 s79, s79, -1
    s_mov_b64 exec, 3
    global_load_dword v10, v60, s[78:79]
    s_mov_b64 exec, -1
    s_cmp_eq_u32 s71, 1
    s_branch L_p_500032
L_p_500032:
    s_cbranch_scc1 L_it1_514031
    v_mov_b32 v56, -1
    v_mov_b32 v57, -1
    v_mov_b32 v58, -1
    v_mov_b32 v59, -1
    s_mul_i32 s79, s64, 49152
    s_mul_i32 s78, s65, 1536
    s_add_u32 s79, s79, s78
    s_mul_i32 s78, s66, 384
    s_add_u32 s79, s79, s78
    s_add_u32 s79, s79, 1441792
    s_mov_b64 exec, 16777215
    buffer_store_dwordx4 v[56:59], v6, s[48:51], s79 offen sc1
    s_mov_b64 exec, -1
    s_branch L_p_500033
L_p_500033:
    v_lshrrev_b32 v60, 3, v0
    v_lshlrev_b32 v60, 6, v60
    v_and_or_b32 v60, v0, 7, v60
    v_lshlrev_b32 v60, 7, v60
    s_lshl_b32 s79, s64, 10
    s_mul_i32 s78, s65, 393216
    s_add_u32 s79, s79, s78
    s_mul_i32 s78, s66, 98304
    s_add_u32 s79, s79, s78
    s_add_u32 s79, s79, 4285530112
    buffer_load_dword v10, v60, s[36:39], s79 offen
    s_add_u32 s79, s79, 65536
    s_mov_b32 exec_lo, 4294967295
    s_mov_b32 exec_hi, 0
    s_branch L_p_500034
L_p_500034:
    buffer_load_dword v10, v60, s[36:39], s79 offen
    s_add_u32 s79, s79, 65536
    s_mov_b64 exec, -1
    v_lshlrev_b32 v60, 7, v0
    s_mul_i32 s79, s64, 589824
    s_mul_i32 s78, s65, 73728
    s_add_u32 s79, s79, s78
    s_mul_i32 s78, s66, 18432
    s_add_u32 s79, s79, s78
    s_add_u32 s79, s79, 4293197824
    buffer_load_dword v10, v60, s[44:47], s79 offen
    s_add_u32 s79, s79, 8192
    buffer_load_dword v10, v60, s[44:47], s79 offen
    s_add_u32 s79, s79, 8192
    s_branch L_p_500035
L_p_500035:
    s_mov_b32 exec_lo, 65535
    s_mov_b32 exec_hi, 0
    buffer_load_dword v10, v60, s[44:47], s79 offen
    s_add_u32 s79, s79, 8192
    s_mov_b64 exec, -1
    s_branch L_it1_514032
L_it1_514031:
    s_sleep 30
L_it1_514032:
    s_waitcnt vmcnt(0)
    s_nop 1
    s_branch L_back_500008
L_cs_500037:
    buffer_load_dwordx4 v[16:19], v33, s[52:55], s4 offen offset:2048 sc1
    buffer_load_dwordx4 v[20:23], v33, s[52:55], s4 offen offset:3072 sc1
    s_branch L_csb_500038
L_retry_500040:
    s_cselect_b32 s3, 1, 0
    s_add_u32 s72, s72, 1
    s_cmp_gt_u32 s72, 200000
    s_nop 1
    s_cbranch_scc0 L_poll_500036
    s_cmp_eq_u32 s3, 1
    s_branch L_got_500039
L_retry_500042:
    s_cselect_b32 s3, 1, 0
    s_add_u32 s72, s72, 1
    s_cmp_gt_u32 s72, 200000
    s_nop 1
    s_cbranch_scc0 L_poll_500036
    s_cmp_eq_u32 s3, 1
    s_branch L_got_500041
L_res_500044:
    s_nop 1
    v_lshlrev_b32 v8, 2, v0
    s_add_u32 s80, s20, 0
    s_mov_b64 exec, 0xfff
L_poll_524046:
    s_add_u32 s81, s80, 0
    buffer_load_dword v10, v8, s[56:59], s81 offen offset:0 sc1
    buffer_load_dword v11, v8, s[56:59], s81 offen offset:3072 sc1
    s_add_u32 s81, s80, 6144
    buffer_load_dword v12, v8, s[56:59], s81 offen offset:0 sc1
    buffer_load_dword v13, v8, s[56:59], s81 offen offset:3072 sc1
    s_add_u32 s81, s80, 12288
    buffer_load_dword v14, v8, s[56:59], s81 offen offset:0 sc1
    s_branch L_resp_500046
L_resp_500046:
    buffer_load_dword v15, v8, s[56:59], s81 offen offset:3072 sc1
    s_add_u32 s81, s80, 18432
    buffer_load_dword v16, v8, s[56:59], s81 offen offset:0 sc1
    buffer_load_dword v17, v8, s[56:59], s81 offen offset:3072 sc1
    v_mov_b32 v18, 0x3f80
    v_mov_b32 v19, 0x3f800000
    v_mov_b64 v[20:21], v[4:5]
    s_waitcnt vmcnt(6)
    v_dot2c_f32_bf16 v20, v18, v10
    v_dot2c_f32_bf16 v21, v19, v10
    v_dot2c_f32_bf16 v20, v18, v11
    v_dot2c_f32_bf16 v21, v19, v11
    s_waitcnt vmcnt(4)
    v_dot2c_f32_bf16 v20, v18, v12
    s_branch L_resp_500047
L_resp_500047:
    v_dot2c_f32_bf16 v21, v19, v12
    v_dot2c_f32_bf16 v20, v18, v13
    v_dot2c_f32_bf16 v21, v19, v13
    s_waitcnt vmcnt(2)
    v_dot2c_f32_bf16 v20, v18, v14
    v_dot2c_f32_bf16 v21, v19, v14
    v_dot2c_f32_bf16 v20, v18, v15
    v_dot2c_f32_bf16 v21, v19, v15
    s_waitcnt vmcnt(0)
    v_dot2c_f32_bf16 v20, v18, v16
    v_dot2c_f32_bf16 v21, v19, v16
    v_dot2c_f32_bf16 v20, v18, v17
    v_dot2c_f32_bf16 v21, v19, v17
    s_nop 2
    s_branch L_resp_500048
L_resp_500048:
    v_cmp_u_f32 vcc, v20, v21
    s_cbranch_vccnz L_retry_524050
L_got_524049:
    v_mov_b64 v[4:5], v[20:21]
    s_mov_b64 exec, -1
    s_branch L_resback_500045
L_retry_524050:
    s_cselect_b32 s3, 1, 0
    s_add_u32 s72, s72, 1
    s_cmp_gt_u32 s72, 200000
    s_cbranch_scc0 L_poll_524046
    s_cmp_eq_u32 s3, 1
    s_branch L_got_524049
L_go_500049:
    s_nop 1
    s_mov_b64 s[80:81], s[0:1]
    s_mov_b32 s82, 0x10000
    s_mov_b32 s83, 0x20000
    v_lshrrev_b32 v19, 4, v0
    v_lshlrev_b32 v18, 5, v19
    v_xor_b32 v18, v18, v6
    v_and_b32 v18, 0xf0, v18
    v_lshl_or_b32 v18, v19, 10, v18
    v_xor_b32 v19, 0, v18
    s_not_b64 exec, s[84:85]
    s_add_u32 m0, s69, 73728
    s_mov_b32 s79, 32768
    s_branch L_p_500051
L_p_500051:
    buffer_load_dwordx4 v19, s[80:83], s79 offen nt lds
    s_add_u32 m0, s69, 77824
    s_mov_b32 s79, 49152
    buffer_load_dwordx4 v19, s[80:83], s79 offen nt lds
    s_mov_b64 exec, -1
    v_xor_b32 v19, 128, v18
    s_mov_b64 exec, s[84:85]
    s_add_u32 m0, s69, 74752
    s_mov_b32 s79, 36864
    buffer_load_dwordx4 v19, s[80:83], s79 offen nt lds
    s_add_u32 m0, s69, 78848
    s_mov_b32 s79, 53248
    buffer_load_dwordx4 v19, s[80:83], s79 offen nt lds
    s_mov_b64 exec, -1
    s_branch L_p_500052
L_p_500052:
    v_xor_b32 v19, 144, v18
    s_mov_b64 exec, s[84:85]
    s_add_u32 m0, s69, 75776
    s_mov_b32 s79, 40960
    buffer_load_dwordx4 v19, s[80:83], s79 offen nt lds
    s_add_u32 m0, s69, 79872
    s_mov_b32 s79, 57344
    buffer_load_dwordx4 v19, s[80:83], s79 offen nt lds
    s_mov_b64 exec, -1
    v_xor_b32 v19, 16, v18
    s_not_b64 exec, s[84:85]
    s_add_u32 m0, s69, 76800
    s_mov_b32 s79, 45056
    buffer_load_dwordx4 v19, s[80:83], s79 offen nt lds
    s_branch L_p_500053
L_p_500053:
    s_add_u32 m0, s69, 80896
    s_mov_b32 s79, 61440
    buffer_load_dwordx4 v19, s[80:83], s79 offen nt lds
    s_mov_b64 exec, -1
    v_mov_b32 v12, -1
    v_mov_b32 v13, -1
    v_mov_b32 v14, -1
    v_mov_b32 v15, -1
    v_lshrrev_b32 v16, 4, v0
    v_and_b32 v17, 0xf0, v6
    v_lshl_or_b32 v16, v16, 16, v17
    s_add_u32 s79, s8, 0
    buffer_store_dwordx4 v[12:15], v16, s[48:51], s79 offen sc1
    s_add_u32 s79, s8, 4096
    s_branch L_p_500054
L_p_500054:
    buffer_store_dwordx4 v[12:15], v16, s[48:51], s79 offen sc1
    s_add_u32 s79, s8, 8192
    buffer_store_dwordx4 v[12:15], v16, s[48:51], s79 offen sc1
    s_add_u32 s79, s8, 12288
    buffer_store_dwordx4 v[12:15], v16, s[48:51], s79 offen sc1
    s_sleep 2
    s_nop 1
    s_branch L_back_500050
L_retry_500059:
    s_cmp_gt_u32 s72, 200000
    s_cbranch_scc1 L_got_500058
    s_mov_b32 m0, s68
    s_mov_b32 exec_lo, 4294967295
    s_mov_b32 exec_hi, 0
    buffer_load_dword v9, v8, s[56:59], s7 offen sc1
    s_mov_b64 exec, -1
    buffer_load_dwordx4 v58, s[56:59], s7 offen offset:0 sc1 lds
    buffer_load_dwordx4 v58, s[56:59], s7 offen offset:1024 sc1 lds
    buffer_load_dwordx4 v58, s[56:59], s7 offen offset:2048 sc1 lds
    buffer_load_dwordx4 v58, s[56:59], s7 offen offset:3072 sc1 lds
    s_add_u32 s72, s72, 1
    s_nop 0
    s_branch L_chk_500056
L_retry_500062:
    s_cselect_b32 s3, 1, 0
    s_add_u32 s72, s72, 1
    s_cmp_gt_u32 s72, 200000
    s_nop 1
    s_cbranch_scc0 L_again_500060
    s_cmp_eq_u32 s3, 1
    s_branch L_got_500061
L_again_500060:
    s_waitcnt lgkmcnt(0)
    v_and_b32 v58, 12, v0
    v_lshlrev_b32 v58, 4, v58
    v_and_or_b32 v58, v0, 48, v58
    v_lshlrev_b32 v58, 2, v58
    v_and_or_b32 v58, v6, 48, v58
    v_lshlrev_b32 v8, 7, v0
    v_mov_b32 v9, 0
    s_barrier
    s_branch L_poll_500055
L_retry_500066:
    s_cmp_gt_u32 s72, 200000
    s_cbranch_scc1 L_got_500065
    buffer_load_dwordx2 v[22:23], v60, s[52:55], s11 offen sc1
    s_add_u32 s72, s72, 1
    s_waitcnt vmcnt(1)
    s_branch L_chk_500063
L_retry_500070:
    s_cselect_b32 s3, 1, 0
    s_add_u32 s72, s72, 1
    s_cmp_gt_u32 s72, 200000
    s_nop 1
    s_cbranch_scc0 L_again_500068
    s_cmp_eq_u32 s3, 1
    s_branch L_got_500069
L_again_500068:
    buffer_load_dwordx4 v[8:11], v6, s[48:51], s10 offen offset:0 sc1
    buffer_load_dwordx4 v[12:15], v6, s[48:51], s10 offen offset:1024 sc1
    buffer_load_dwordx4 v[16:19], v6, s[48:51], s10 offen offset:2048 sc1
    buffer_load_dwordx4 v[20:23], v6, s[48:51], s10 offen offset:3072 sc1
    v_mov_b64 v[28:29], 0
    v_mov_b64 v[30:31], 0
    v_mov_b64 v[32:33], 0
    v_mov_b64 v[34:35], 0
    s_waitcnt vmcnt(0)
    s_branch L_acc_500067
L_go_500071:
    s_nop 1
    v_mov_b32 v8, -1
    v_mov_b32 v9, -1
    v_mov_b32 v10, -1
    v_mov_b32 v11, -1
    s_mul_i32 s80, s65, 1792
    s_mul_i32 s78, s66, 448
    s_add_u32 s80, s80, s78
    s_add_u32 s80, s80, 73728
    s_mov_b64 exec, 0xfffffff
    buffer_store_dwordx4 v[8:11], v6, s[52:55], s80 offen sc1
    s_mov_b64 exec, -1
    s_nop 1
    s_branch L_p_500073
L_p_500073:
    s_branch L_back_500072
L_retry_500078:
    s_cmp_gt_u32 s72, 200000
    s_cbranch_scc1 L_got_500077
    buffer_load_dword v16, v29, s[56:59], s15 offen sc1
    s_add_u32 s72, s72, 1
    s_waitcnt vmcnt(0)
    s_branch L_chk_500075
L_retry_500080:
    s_cmp_gt_u32 s72, 200000
    s_cbranch_scc1 L_got_500079
    buffer_load_dwordx4 v[8:11], v28, s[56:59], s14 offen sc1
    s_nop 7
    v_mov_b64 v[20:21], 0
    v_mov_b64 v[22:23], 0
    v_mov_b64 v[24:25], 0
    v_mov_b64 v[26:27], 0
    s_add_u32 s72, s72, 1
    s_waitcnt vmcnt(0)
    s_branch L_chk_500076
L_retry_500082:
    s_cmp_gt_u32 s72, 200000
    s_cbranch_scc1 L_got_500081
    buffer_load_dwordx4 v[8:11], v28, s[56:59], s14 offen sc1
    v_mov_b64 v[20:21], 0
    v_mov_b64 v[22:23], 0
    v_mov_b64 v[24:25], 0
    v_mov_b64 v[26:27], 0
    s_add_u32 s72, s72, 1
    s_waitcnt vmcnt(0)
    s_branch L_chk_500076
L_retry_500087:
    s_cselect_b32 s3, 1, 0
    s_add_u32 s72, s72, 1
    s_cmp_gt_u32 s72, 200000
    s_nop 1
    s_cbranch_scc0 L_poll_500085
    s_cmp_eq_u32 s3, 1
    s_branch L_got_500086
L_retry_500089:
    s_cselect_b32 s3, 1, 0
    s_add_u32 s72, s72, 1
    s_cmp_gt_u32 s72, 200000
    s_nop 1
    s_cbranch_scc0 L_poll_500085
    s_cmp_eq_u32 s3, 1
    s_branch L_got_500088
L_retry_500094:
    s_cmp_gt_u32 s72, 200000
    s_cbranch_scc1 L_got_500093
    s_mov_b32 m0, s83
    s_mov_b64 exec, 0x77777777
    buffer_load_dword v13, v12, s[56:59], s82 offen sc1
    buffer_load_dwordx4 v12, s[56:59], s82 offen sc1 lds
    s_mov_b64 exec, -1
    s_add_u32 s72, s72, 1
    s_waitcnt vmcnt(0)
    s_branch L_chk_500091
L_retry_500097:
    s_cselect_b32 s3, 1, 0
    s_add_u32 s72, s72, 1
    s_cmp_gt_u32 s72, 200000
    s_nop 1
    s_cbranch_scc0 L_again_500095
    s_cmp_eq_u32 s3, 1
    s_branch L_got_500096
L_again_500095:
    s_barrier
    s_branch L_retry_500094
L_go_500083:
    s_nop 1
    s_cmp_eq_u32 s71, 1
    s_cbranch_scc1 L_final_slow
    s_add_u32 s52, s52, 73728
    s_addc_u32 s53, s53, 0
    s_mov_b32 s54, 57344
    s_mov_b32 s71, 1
    v_lshlrev_b32 v60, 7, v0
    s_lshl_b32 s79, s64, 17
    s_lshl_b32 s78, s65, 12
    s_add_u32 s79, s79, s78
    s_lshl_b32 s78, s66, 10
    s_add_u32 s79, s79, s78
    s_branch L_p_500098
L_p_500098:
    s_mov_b32 exec_lo, 255
    s_mov_b32 exec_hi, 0
    buffer_load_dword v10, v60, s[48:51], s79 offen
    s_mov_b64 exec, -1
    s_sleep 30
    s_waitcnt vmcnt(0)
    s_barrier
    s_nop 1
    s_branch L_back_500084
L_retry_500103:
    s_cselect_b32 s3, 1, 0
    s_add_u32 s72, s72, 1
    s_cmp_gt_u32 s72, 200000
    s_cbranch_scc0 L_poll_500099
    s_cmp_eq_u32 s3, 1
    s_branch L_got_500102
L_retry_500105:
    s_cselect_b32 s3, 1, 0
    s_add_u32 s72, s72, 1
    s_cmp_gt_u32 s72, 200000
    s_nop 1
    s_cbranch_scc0 L_poll_500099
    s_cmp_eq_u32 s3, 1
    s_branch L_got_500104
L_retry_500108:
    s_cmp_gt_u32 s72, 200000
    s_cbranch_scc1 L_got_500107
    buffer_load_dword v10, v8, s[56:59], s80 offen sc1
    buffer_load_dword v11, v8, s[56:59], s81 offen sc1
    s_nop 1
    v_mov_b64 v[14:15], v[4:5]
    s_add_u32 s72, s72, 1
    s_waitcnt vmcnt(0)
    s_branch L_chk_500106
    s_endpgm
.section .rodata,"a"
.p2align 6
.amdhsa_kernel interleave_layers__mha_block_cached__compressed_kv_cla__decode_kernel
  .amdhsa_next_free_vgpr 512
  .amdhsa_next_free_sgpr 102
  .amdhsa_accum_offset 256
  .amdhsa_group_segment_fixed_size 0
  .amdhsa_kernarg_size 112
  .amdhsa_user_sgpr_count 2
  .amdhsa_user_sgpr_kernarg_segment_ptr 1
  .amdhsa_system_sgpr_workgroup_id_x 1
.end_amdhsa_kernel
```
